```python
import torch

def _softmax(x, axis=-1):
    return torch.softmax(x, dim=axis)
def _gelu(x):
    return torch.nn.functional.gelu(x, approximate="tanh")
def _silu(x):
    return torch.nn.functional.silu(x)
def _sigmoid(x):
    return torch.sigmoid(x)
def _layernorm(x, axis=-1, eps=1e-5):
    m = x.mean(dim=axis, keepdim=True)
    v = x.var(dim=axis, keepdim=True, unbiased=False)
    return (x - m) / torch.sqrt(v + eps)
def _scatter_add(tgt, idx, src, axis=0):
    return tgt.clone().index_add_(axis, idx, src)
def _segment_sum(src, seg, n):
    out = torch.zeros((n,) + src.shape[1:], dtype=src.dtype)
    return out.index_add_(0, seg, src)
def _pad(x, pw):
    flat = tuple(v for pair in reversed(pw) for v in pair)
    return torch.nn.functional.pad(x, flat)

kernel_name = 'standalone__mha_block_cached__near_ridge'

def setup_inputs():

    _w = (lambda a: (lambda t: t.to(torch.bfloat16) if t.is_floating_point() else t)(torch.as_tensor(a)))
    B, Sq, D = 8, 208, 512
    H, Sk, Dh = 32, 512, 128
    return {
        "x": _w((lambda *s: torch.randn(*s, dtype=torch.bfloat16) * 0.8)(B, Sq, D)),
        "k_cache": _w((lambda *s: torch.randn(*s, dtype=torch.bfloat16) * 0.8)(B, H, Sk, Dh)),
        "v_cache": _w((lambda *s: torch.randn(*s, dtype=torch.bfloat16) * 0.05)(B, H, Sk, Dh)),
        "wq": _w((lambda *s: torch.randn(*s, dtype=torch.bfloat16) * 0.8)(D, H * Dh) * (D ** -0.5)),
        "wo": _w((lambda *s: torch.randn(*s, dtype=torch.bfloat16) * 0.05)(H * Dh, D) * ((H * Dh) ** -0.5)),
    }

def reference(x, k_cache, v_cache, wq, wo):
    B, Sq, D = x.shape
    H, Dh = 32, 128
    q = (lambda x, *d: x.permute(*d))((x @ wq).reshape(B, Sq, H, Dh), 0, 2, 1, 3)
    scores = torch.einsum("bhqd,bhkd->bhqk", q, k_cache) * (Dh ** -0.5)
    p = _softmax(scores, axis=-1)
    o = torch.einsum("bhqk,bhkd->bhqd", p, v_cache)
    return (lambda x, *d: x.permute(*d))(o, 0, 2, 1, 3).reshape(B, Sq, H * Dh) @ wo
```

```asm
; @launch grid=(256,1,1) block=(512,1,1) lds=163840
.amdgcn_target "amdgcn-amd-amdhsa--gfx950"
.text
.globl standalone__mha_block_cached__near_ridge_kernel
.p2align 8
.type standalone__mha_block_cached__near_ridge_kernel,@function
standalone__mha_block_cached__near_ridge_kernel:
L_k_start:
    s_cmp_ge_u32 s2, 0x100
    s_cbranch_scc1 L_k_end
    s_load_dwordx16 s[28:43], s[0:1], 0
    v_lshrrev_b32 v2, 6, v0
    v_and_b32 v1, 63, v0
    v_readfirstlane_b32 s44, v2
    s_and_b32 s47, s2, 1
    s_lshl_b32 s47, s47, 2
    s_lshr_b32 s48, s2, 6
    s_add_u32 s45, s47, s48
    s_bfe_u32 s82, s2, 0x20001
    s_lshl_b32 s47, s82, 3
    s_bfe_u32 s81, s2, 0x30003
    s_add_u32 s46, s47, s81
    s_mov_b32 s77, 0x8400
    s_mov_b32 s80, 0x61a80
    s_lshl_b32 s78, s48, 1
    s_add_u32 s78, s78, s81
    v_lshlrev_b32 v3, 2, v1
    v_add_u32 v3, 0x26280, v3
    v_mov_b32 v4, 0
    ds_write_b32 v3, v4
    v_mov_b32 v0, 0x26280
    s_sub_u32 s60, s44, 4
    s_and_b32 s76, s44, 1
    s_cmp_ge_u32 s44, 4
    s_cbranch_scc1 L_k_helper
    s_setprio 2
    v_and_b32 v5, 7, v1
    v_mul_u32_u24 v2, 0x420, v5
    v_bfe_u32 v5, v1, 3, 1
    v_lshl_add_u32 v2, v5, 8, v2
    v_lshrrev_b32 v5, 4, v1
    v_lshl_add_u32 v2, v5, 4, v2
    v_bfe_u32 v5, v1, 2, 3
    v_mul_u32_u24 v3, 0x420, v5
    v_lshrrev_b32 v5, 5, v1
    v_lshl_add_u32 v3, v5, 8, v3
    v_and_b32 v5, 3, v1
    v_lshl_add_u32 v3, v5, 3, v3
    v_lshrrev_b32 v5, 5, v1
    v_lshl_add_u32 v4, v5, 8, v3
    v_add_u32 v4, 0x15a80, v4
    s_lshl_b32 s47, s44, 6
    v_add_u32 v12, s47, v4
    v_and_b32 v5, 3, v1
    v_mul_u32_u24 v5, 0x420, v5
    v_bfe_u32 v6, v1, 2, 2
    v_lshl_add_u32 v5, v6, 7, v5
    v_lshrrev_b32 v6, 4, v1
    v_lshl_add_u32 v5, v6, 4, v5
    s_mul_i32 s47, s44, 3
    s_add_u32 s47, s47, 0
    s_lshr_b32 s48, s47, 1
    s_mul_i32 s48, s48, 0x1080
    s_and_b32 s47, s47, 1
    s_lshl_b32 s47, s47, 9
    s_add_u32 s47, s47, s48
    s_add_u32 s47, s47, 0
    v_add_u32 v8, s47, v5
    s_mul_i32 s47, s44, 3
    s_add_u32 s47, s47, 1
    s_lshr_b32 s48, s47, 1
    s_mul_i32 s48, s48, 0x1080
    s_and_b32 s47, s47, 1
    s_lshl_b32 s47, s47, 9
    s_add_u32 s47, s47, s48
    s_add_u32 s47, s47, 0
    v_add_u32 v9, s47, v5
    s_mul_i32 s47, s44, 3
    s_add_u32 s47, s47, 2
    s_lshr_b32 s48, s47, 1
    s_mul_i32 s48, s48, 0x1080
    s_and_b32 s47, s47, 1
    s_lshl_b32 s47, s47, 9
    s_add_u32 s47, s47, s48
    s_add_u32 s47, s47, 0
    v_add_u32 v10, s47, v5
    v_and_b32 v5, 1, v1
    v_mul_u32_u24 v5, 0x420, v5
    v_bfe_u32 v7, v1, 1, 3
    v_lshl_add_u32 v5, v7, 7, v5
    v_lshl_add_u32 v5, v6, 4, v5
    v_add_u32 v11, 0x6300, v5
    s_lshl_b32 s47, s44, 2
    s_add_u32 s47, s47, 0x26280
    v_mov_b32 v69, s47
    s_mov_b32 s58, 0x3e0293ee
    s_mov_b32 s59, 0x3e0293ee
    s_waitcnt lgkmcnt(0)
    s_barrier
    v_mov_b32 v72, 0
    v_mov_b32 v73, 0
    v_mov_b32 v74, 0
    v_mov_b32 v75, 0
    v_mov_b32 v76, 0
    v_mov_b32 v77, 0
    v_mov_b32 v78, 0
    v_mov_b32 v79, 0
    v_mov_b32 v80, 0
    v_mov_b32 v81, 0
    v_mov_b32 v82, 0
    v_mov_b32 v83, 0
    v_mov_b32 v84, 0
    v_mov_b32 v85, 0
    v_mov_b32 v86, 0
    v_mov_b32 v87, 0
    v_mov_b32 v88, 0
    v_mov_b32 v89, 0
    v_mov_b32 v90, 0
    v_mov_b32 v91, 0
    v_mov_b32 v92, 0
    v_mov_b32 v93, 0
    v_mov_b32 v94, 0
    v_mov_b32 v95, 0
    v_mov_b32 v96, 0
    v_mov_b32 v97, 0
    v_mov_b32 v98, 0
    v_mov_b32 v99, 0
    v_mov_b32 v100, 0
    v_mov_b32 v101, 0
    v_mov_b32 v102, 0
    v_mov_b32 v103, 0
    v_mov_b32 v104, 0
    v_mov_b32 v105, 0
    v_mov_b32 v106, 0
    v_mov_b32 v107, 0
    v_mov_b32 v108, 0
    v_mov_b32 v109, 0
    v_mov_b32 v110, 0
    v_mov_b32 v111, 0
    v_mov_b32 v112, 0
    v_mov_b32 v113, 0
    v_mov_b32 v114, 0
    v_mov_b32 v115, 0
    v_mov_b32 v116, 0
    v_mov_b32 v117, 0
    v_mov_b32 v118, 0
    v_mov_b32 v119, 0
    v_mov_b32 v120, 0
    v_mov_b32 v121, 0
    v_mov_b32 v122, 0
    v_mov_b32 v123, 0
    v_mov_b32 v124, 0
    v_mov_b32 v125, 0
    v_mov_b32 v126, 0
    v_mov_b32 v127, 0
    v_mov_b32 v128, 0
    v_mov_b32 v129, 0
    v_mov_b32 v130, 0
    v_mov_b32 v131, 0
    v_mov_b32 v132, 0
    v_mov_b32 v133, 0
    v_mov_b32 v134, 0
    v_mov_b32 v135, 0
    v_mov_b32 v136, 0
    v_mov_b32 v137, 0
    v_mov_b32 v138, 0
    v_mov_b32 v139, 0
    v_mov_b32 v140, 0
    v_mov_b32 v141, 0
    v_mov_b32 v142, 0
    v_mov_b32 v143, 0
    v_mov_b32 v144, 0
    v_mov_b32 v145, 0
    v_mov_b32 v146, 0
    v_mov_b32 v147, 0
    v_mov_b32 v148, 0
    v_mov_b32 v149, 0
    v_mov_b32 v150, 0
    v_mov_b32 v151, 0
    v_mov_b32 v152, 0
    v_mov_b32 v153, 0
    v_mov_b32 v154, 0
    v_mov_b32 v155, 0
    v_mov_b32 v156, 0
    v_mov_b32 v157, 0
    v_mov_b32 v158, 0
    v_mov_b32 v159, 0
    v_mov_b32 v160, 0
    v_mov_b32 v161, 0
    v_mov_b32 v162, 0
    v_mov_b32 v163, 0
    v_mov_b32 v164, 0
    v_mov_b32 v165, 0
    v_mov_b32 v166, 0
    v_mov_b32 v167, 0
    v_mov_b32 v52, 0
    v_mov_b32 v53, 0
    v_mov_b32 v54, 0
    v_mov_b32 v55, 0
    v_mov_b32 v56, 0
    v_mov_b32 v57, 0
    v_mov_b32 v58, 0
    v_mov_b32 v59, 0
    s_mul_i32 s47, s45, 0x1a0000
    s_lshl_b32 s48, s82, 15
    s_add_u32 s47, s47, s48
    s_add_u32 s16, s42, s47
    s_addc_u32 s17, s43, 0
    s_sub_u32 s18, 0x1a0000, s48
    s_mov_b32 s19, 0x20000
    s_lshl_b32 s47, s45, 3
    s_add_u32 s47, s47, s81
    s_lshl_b32 s84, s47, 7
    s_mul_i32 s47, s47, 0x34000
    s_add_u32 s47, s47, 0x1000000
    s_add_u32 s20, s42, s47
    s_addc_u32 s21, s43, 0
    s_mov_b32 s22, 0x34000
    s_mov_b32 s23, 0x20000
    s_mul_i32 s47, s45, 0x34000
    s_lshl_b32 s48, s81, 7
    s_add_u32 s47, s47, s48
    s_add_u32 s24, s38, s47
    s_addc_u32 s25, s39, 0
    s_sub_u32 s26, 0x1a0000, s47
    s_mov_b32 s27, 0x20000
    s_add_u32 s72, s42, 0x2000000
    s_addc_u32 s73, s43, 0
    s_mov_b32 s74, 0x10000
    s_mov_b32 s75, 0x20000
    s_lshl_b32 s47, s45, 2
    s_add_u32 s47, s47, s82
    s_add_u32 s47, s47, 64
    s_lshl_b32 s83, s47, 7
L_k_poll_cq0:
    ds_read_b32 v70, v0 offset:0
    s_waitcnt lgkmcnt(0)
    v_cmp_gt_u32 vcc, 1, v70
    s_cbranch_vccz L_k_pok_cq0
    s_sub_u32 s80, s80, 1
    s_cbranch_scc0 L_k_poll_cq0
    s_endpgm
L_k_pok_cq0:
    ds_read_b128 v[20:23], v8 offset:0
    ds_read_b128 v[24:27], v9 offset:0
    ds_read_b128 v[28:31], v10 offset:0
    ds_read_b128 v[32:35], v11 offset:0
    ds_read_b128 v[36:39], v8 offset:64
    ds_read_b128 v[40:43], v9 offset:64
    ds_read_b128 v[44:47], v10 offset:64
    ds_read_b128 v[48:51], v11 offset:64
    ds_read_b64_tr_b16 a[0:1], v4 offset:0
    ds_read_b64_tr_b16 a[2:3], v4 offset:256
    ds_read_b64_tr_b16 a[4:5], v4 offset:32
    ds_read_b64_tr_b16 a[6:7], v4 offset:288
    ds_read_b64_tr_b16 a[8:9], v4 offset:64
    ds_read_b64_tr_b16 a[10:11], v4 offset:320
    ds_read_b64_tr_b16 a[12:13], v4 offset:96
    ds_read_b64_tr_b16 a[14:15], v4 offset:352
    s_mov_b32 s79, 2
    v_mov_b32 v70, s79
    ds_write_b32 v69, v70 offset:16
    s_mov_b32 s52, 2
    s_mov_b32 s51, 0
    s_mov_b32 s54, 0
    s_mov_b32 s57, 0x6b40
L_k_cq_loop:
    s_waitcnt lgkmcnt(4)
    v_mfma_f32_16x16x32_bf16 v[72:75], a[0:3], v[20:23], v[72:75]
    ds_read_b64_tr_b16 a[16:17], v4 offset:128
    v_mfma_f32_16x16x32_bf16 v[104:107], a[0:3], v[24:27], v[104:107]
    ds_read_b64_tr_b16 a[18:19], v4 offset:384
    v_mfma_f32_16x16x32_bf16 v[136:139], a[0:3], v[28:31], v[136:139]
    ds_read_b64_tr_b16 v[60:61], v12 offset:0
    v_mfma_f32_16x16x32_bf16 v[76:79], a[4:7], v[20:23], v[76:79]
    ds_read_b64_tr_b16 a[20:21], v4 offset:160
    s_add_u32 s54, s54, 1
    s_cmp_ge_u32 s54, 3
    s_cselect_b32 s56, 0xffff2980, s57
    s_cselect_b32 s54, 0, s54
    v_mfma_f32_16x16x32_bf16 v[108:111], a[4:7], v[24:27], v[108:111]
    ds_read_b64_tr_b16 a[22:23], v4 offset:416
    v_mfma_f32_16x16x32_bf16 v[140:143], a[4:7], v[28:31], v[140:143]
    ds_read_b64_tr_b16 v[62:63], v12 offset:256
    s_waitcnt lgkmcnt(6)
    v_mfma_f32_16x16x32_bf16 v[80:83], a[8:11], v[20:23], v[80:83]
    ds_read_b64_tr_b16 a[24:25], v4 offset:192
    v_mfma_f32_16x16x32_bf16 v[112:115], a[8:11], v[24:27], v[112:115]
    ds_read_b64_tr_b16 a[26:27], v4 offset:448
    v_mfma_f32_16x16x32_bf16 v[144:147], a[8:11], v[28:31], v[144:147]
    ds_read_b32 v70, v0 offset:4
    ds_read_b64_tr_b16 v[64:65], v12 offset:32
    v_add_u32 v8, s56, v8
    v_add_u32 v9, s56, v9
    v_mfma_f32_16x16x32_bf16 v[84:87], a[12:15], v[20:23], v[84:87]
    ds_read_b64_tr_b16 a[28:29], v4 offset:224
    v_mfma_f32_16x16x32_bf16 v[116:119], a[12:15], v[24:27], v[116:119]
    ds_read_b64_tr_b16 a[30:31], v4 offset:480
    v_mfma_f32_16x16x32_bf16 v[148:151], a[12:15], v[28:31], v[148:151]
    ds_read_b64_tr_b16 v[66:67], v12 offset:288
    v_add_u32 v10, s56, v10
    v_add_u32 v11, s56, v11
    s_waitcnt lgkmcnt(11)
    v_mfma_f32_16x16x32_bf16 v[88:91], a[16:19], v[20:23], v[88:91]
    s_waitcnt lgkmcnt(4)
    v_cmp_gt_u32 vcc, s52, v70
    s_cbranch_vccnz L_k_spin_cq0
L_k_ret_cq0:
    s_add_u32 s52, s52, 1
    v_mfma_f32_16x16x32_bf16 v[120:123], a[16:19], v[24:27], v[120:123]
    ds_read_b64_tr_b16 a[0:1], v4 offset:8448
    v_mfma_f32_16x16x32_bf16 v[152:155], a[16:19], v[28:31], v[152:155]
    ds_read_b64_tr_b16 a[2:3], v4 offset:8704
    ds_read_b128 v[168:171], v8 offset:0
    ds_read_b128 v[172:175], v9 offset:0
    v_mfma_f32_16x16x32_bf16 v[92:95], a[20:23], v[20:23], v[92:95]
    ds_read_b64_tr_b16 a[4:5], v4 offset:8480
    v_mfma_f32_16x16x32_bf16 v[124:127], a[20:23], v[24:27], v[124:127]
    ds_read_b64_tr_b16 a[6:7], v4 offset:8736
    v_mfma_f32_16x16x32_bf16 v[156:159], a[20:23], v[28:31], v[156:159]
    ds_read_b128 v[176:179], v10 offset:0
    ds_read_b128 v[180:183], v11 offset:0
    v_mfma_f32_16x16x32_bf16 v[52:55], v[60:63], v[32:35], v[52:55]
    v_mfma_f32_16x16x32_bf16 v[96:99], a[24:27], v[20:23], v[96:99]
    ds_read_b64_tr_b16 a[8:9], v4 offset:8512
    v_mfma_f32_16x16x32_bf16 v[128:131], a[24:27], v[24:27], v[128:131]
    ds_read_b64_tr_b16 a[10:11], v4 offset:8768
    v_mfma_f32_16x16x32_bf16 v[160:163], a[24:27], v[28:31], v[160:163]
    ds_read_b128 v[184:187], v8 offset:64
    ds_read_b128 v[188:191], v9 offset:64
    s_waitcnt lgkmcnt(10)
    v_mfma_f32_16x16x32_bf16 v[56:59], v[64:67], v[32:35], v[56:59]
    v_mfma_f32_16x16x32_bf16 v[100:103], a[28:31], v[20:23], v[100:103]
    ds_read_b64_tr_b16 a[12:13], v4 offset:8544
    v_mfma_f32_16x16x32_bf16 v[132:135], a[28:31], v[24:27], v[132:135]
    ds_read_b64_tr_b16 a[14:15], v4 offset:8800
    v_mfma_f32_16x16x32_bf16 v[164:167], a[28:31], v[28:31], v[164:167]
    ds_read_b128 v[192:195], v10 offset:64
    ds_read_b128 v[196:199], v11 offset:64
    s_add_u32 s79, s79, 3
    v_mov_b32 v70, s79
    ds_write_b32 v69, v70 offset:16
    v_mfma_f32_16x16x32_bf16 v[72:75], a[0:3], v[36:39], v[72:75]
    ds_read_b64_tr_b16 a[16:17], v4 offset:8576
    v_mfma_f32_16x16x32_bf16 v[104:107], a[0:3], v[40:43], v[104:107]
    ds_read_b64_tr_b16 a[18:19], v4 offset:8832
    v_mfma_f32_16x16x32_bf16 v[136:139], a[0:3], v[44:47], v[136:139]
    ds_read_b64_tr_b16 v[60:61], v12 offset:8448
    s_waitcnt lgkmcnt(10)
    v_mfma_f32_16x16x32_bf16 v[76:79], a[4:7], v[36:39], v[76:79]
    ds_read_b64_tr_b16 a[20:21], v4 offset:8608
    v_mfma_f32_16x16x32_bf16 v[108:111], a[4:7], v[40:43], v[108:111]
    ds_read_b64_tr_b16 a[22:23], v4 offset:8864
    v_mfma_f32_16x16x32_bf16 v[140:143], a[4:7], v[44:47], v[140:143]
    ds_read_b64_tr_b16 v[62:63], v12 offset:8704
    v_mfma_f32_16x16x32_bf16 v[80:83], a[8:11], v[36:39], v[80:83]
    ds_read_b64_tr_b16 a[24:25], v4 offset:8640
    v_mfma_f32_16x16x32_bf16 v[112:115], a[8:11], v[40:43], v[112:115]
    ds_read_b64_tr_b16 a[26:27], v4 offset:8896
    v_mfma_f32_16x16x32_bf16 v[144:147], a[8:11], v[44:47], v[144:147]
    ds_read_b64_tr_b16 v[64:65], v12 offset:8480
    s_waitcnt lgkmcnt(7)
    v_mfma_f32_16x16x32_bf16 v[84:87], a[12:15], v[36:39], v[84:87]
    ds_read_b64_tr_b16 a[28:29], v4 offset:8672
    v_mfma_f32_16x16x32_bf16 v[116:119], a[12:15], v[40:43], v[116:119]
    ds_read_b64_tr_b16 a[30:31], v4 offset:8928
    v_mfma_f32_16x16x32_bf16 v[148:151], a[12:15], v[44:47], v[148:151]
    ds_read_b64_tr_b16 v[66:67], v12 offset:8736
    s_add_u32 s79, s79, 1
    v_mfma_f32_16x16x32_bf16 v[88:91], a[16:19], v[36:39], v[88:91]
    v_mov_b32 v70, s79
    ds_write_b32 v69, v70 offset:16
    v_mfma_f32_16x16x32_bf16 v[120:123], a[16:19], v[40:43], v[120:123]
    ds_read_b64_tr_b16 a[0:1], v4 offset:16896
    v_mfma_f32_16x16x32_bf16 v[152:155], a[16:19], v[44:47], v[152:155]
    ds_read_b64_tr_b16 a[2:3], v4 offset:17152
    s_waitcnt lgkmcnt(9)
    v_mfma_f32_16x16x32_bf16 v[92:95], a[20:23], v[36:39], v[92:95]
    ds_read_b64_tr_b16 a[4:5], v4 offset:16928
    v_mfma_f32_16x16x32_bf16 v[124:127], a[20:23], v[40:43], v[124:127]
    ds_read_b64_tr_b16 a[6:7], v4 offset:17184
    v_mfma_f32_16x16x32_bf16 v[156:159], a[20:23], v[44:47], v[156:159]
    v_mfma_f32_16x16x32_bf16 v[52:55], v[60:63], v[48:51], v[52:55]
    s_waitcnt lgkmcnt(5)
    v_mfma_f32_16x16x32_bf16 v[96:99], a[24:27], v[36:39], v[96:99]
    ds_read_b64_tr_b16 a[8:9], v4 offset:16960
    v_mfma_f32_16x16x32_bf16 v[128:131], a[24:27], v[40:43], v[128:131]
    ds_read_b64_tr_b16 a[10:11], v4 offset:17216
    v_mfma_f32_16x16x32_bf16 v[160:163], a[24:27], v[44:47], v[160:163]
    v_mfma_f32_16x16x32_bf16 v[56:59], v[64:67], v[48:51], v[56:59]
    v_mfma_f32_16x16x32_bf16 v[100:103], a[28:31], v[36:39], v[100:103]
    ds_read_b64_tr_b16 a[12:13], v4 offset:16992
    v_mfma_f32_16x16x32_bf16 v[132:135], a[28:31], v[40:43], v[132:135]
    ds_read_b64_tr_b16 a[14:15], v4 offset:17248
    v_mfma_f32_16x16x32_bf16 v[164:167], a[28:31], v[44:47], v[164:167]
    s_waitcnt lgkmcnt(4)
    v_mfma_f32_16x16x32_bf16 v[72:75], a[0:3], v[168:171], v[72:75]
    ds_read_b64_tr_b16 a[16:17], v4 offset:17024
    v_mfma_f32_16x16x32_bf16 v[104:107], a[0:3], v[172:175], v[104:107]
    ds_read_b64_tr_b16 a[18:19], v4 offset:17280
    v_mfma_f32_16x16x32_bf16 v[136:139], a[0:3], v[176:179], v[136:139]
    ds_read_b64_tr_b16 v[60:61], v12 offset:16896
    v_mfma_f32_16x16x32_bf16 v[76:79], a[4:7], v[168:171], v[76:79]
    ds_read_b64_tr_b16 a[20:21], v4 offset:17056
    s_add_u32 s54, s54, 1
    s_cmp_ge_u32 s54, 3
    s_cselect_b32 s56, 0xffff2980, s57
    s_cselect_b32 s54, 0, s54
    v_mfma_f32_16x16x32_bf16 v[108:111], a[4:7], v[172:175], v[108:111]
    ds_read_b64_tr_b16 a[22:23], v4 offset:17312
    v_mfma_f32_16x16x32_bf16 v[140:143], a[4:7], v[176:179], v[140:143]
    ds_read_b64_tr_b16 v[62:63], v12 offset:17152
    s_waitcnt lgkmcnt(6)
    v_mfma_f32_16x16x32_bf16 v[80:83], a[8:11], v[168:171], v[80:83]
    ds_read_b64_tr_b16 a[24:25], v4 offset:17088
    v_mfma_f32_16x16x32_bf16 v[112:115], a[8:11], v[172:175], v[112:115]
    ds_read_b64_tr_b16 a[26:27], v4 offset:17344
    v_mfma_f32_16x16x32_bf16 v[144:147], a[8:11], v[176:179], v[144:147]
    ds_read_b32 v70, v0 offset:0
    ds_read_b64_tr_b16 v[64:65], v12 offset:16928
    v_add_u32 v8, s56, v8
    v_add_u32 v9, s56, v9
    v_mfma_f32_16x16x32_bf16 v[84:87], a[12:15], v[168:171], v[84:87]
    ds_read_b64_tr_b16 a[28:29], v4 offset:17120
    v_mfma_f32_16x16x32_bf16 v[116:119], a[12:15], v[172:175], v[116:119]
    ds_read_b64_tr_b16 a[30:31], v4 offset:17376
    v_mfma_f32_16x16x32_bf16 v[148:151], a[12:15], v[176:179], v[148:151]
    ds_read_b64_tr_b16 v[66:67], v12 offset:17184
    v_add_u32 v10, s56, v10
    v_add_u32 v11, s56, v11
    s_waitcnt lgkmcnt(11)
    v_mfma_f32_16x16x32_bf16 v[88:91], a[16:19], v[168:171], v[88:91]
    s_waitcnt lgkmcnt(4)
    v_cmp_gt_u32 vcc, s52, v70
    s_cbranch_vccnz L_k_spin_cq2
L_k_ret_cq2:
    s_add_u32 s52, s52, 1
    v_mfma_f32_16x16x32_bf16 v[120:123], a[16:19], v[172:175], v[120:123]
    ds_read_b64_tr_b16 a[0:1], v4 offset:25344
    v_mfma_f32_16x16x32_bf16 v[152:155], a[16:19], v[176:179], v[152:155]
    ds_read_b64_tr_b16 a[2:3], v4 offset:25600
    ds_read_b128 v[20:23], v8 offset:0
    ds_read_b128 v[24:27], v9 offset:0
    v_mfma_f32_16x16x32_bf16 v[92:95], a[20:23], v[168:171], v[92:95]
    ds_read_b64_tr_b16 a[4:5], v4 offset:25376
    v_mfma_f32_16x16x32_bf16 v[124:127], a[20:23], v[172:175], v[124:127]
    ds_read_b64_tr_b16 a[6:7], v4 offset:25632
    v_mfma_f32_16x16x32_bf16 v[156:159], a[20:23], v[176:179], v[156:159]
    ds_read_b128 v[28:31], v10 offset:0
    ds_read_b128 v[32:35], v11 offset:0
    v_mfma_f32_16x16x32_bf16 v[52:55], v[60:63], v[180:183], v[52:55]
    v_mfma_f32_16x16x32_bf16 v[96:99], a[24:27], v[168:171], v[96:99]
    ds_read_b64_tr_b16 a[8:9], v4 offset:25408
    v_mfma_f32_16x16x32_bf16 v[128:131], a[24:27], v[172:175], v[128:131]
    ds_read_b64_tr_b16 a[10:11], v4 offset:25664
    v_mfma_f32_16x16x32_bf16 v[160:163], a[24:27], v[176:179], v[160:163]
    ds_read_b128 v[36:39], v8 offset:64
    ds_read_b128 v[40:43], v9 offset:64
    s_waitcnt lgkmcnt(10)
    v_mfma_f32_16x16x32_bf16 v[56:59], v[64:67], v[180:183], v[56:59]
    v_mfma_f32_16x16x32_bf16 v[100:103], a[28:31], v[168:171], v[100:103]
    ds_read_b64_tr_b16 a[12:13], v4 offset:25440
    v_mfma_f32_16x16x32_bf16 v[132:135], a[28:31], v[172:175], v[132:135]
    ds_read_b64_tr_b16 a[14:15], v4 offset:25696
    v_mfma_f32_16x16x32_bf16 v[164:167], a[28:31], v[176:179], v[164:167]
    ds_read_b128 v[44:47], v10 offset:64
    ds_read_b128 v[48:51], v11 offset:64
    s_add_u32 s79, s79, 3
    v_mov_b32 v70, s79
    ds_write_b32 v69, v70 offset:16
    v_mfma_f32_16x16x32_bf16 v[72:75], a[0:3], v[184:187], v[72:75]
    ds_read_b64_tr_b16 a[16:17], v4 offset:25472
    v_mfma_f32_16x16x32_bf16 v[104:107], a[0:3], v[188:191], v[104:107]
    ds_read_b64_tr_b16 a[18:19], v4 offset:25728
    v_mfma_f32_16x16x32_bf16 v[136:139], a[0:3], v[192:195], v[136:139]
    ds_read_b64_tr_b16 v[60:61], v12 offset:25344
    s_waitcnt lgkmcnt(10)
    v_mfma_f32_16x16x32_bf16 v[76:79], a[4:7], v[184:187], v[76:79]
    ds_read_b64_tr_b16 a[20:21], v4 offset:25504
    v_mfma_f32_16x16x32_bf16 v[108:111], a[4:7], v[188:191], v[108:111]
    ds_read_b64_tr_b16 a[22:23], v4 offset:25760
    v_mfma_f32_16x16x32_bf16 v[140:143], a[4:7], v[192:195], v[140:143]
    ds_read_b64_tr_b16 v[62:63], v12 offset:25600
    v_mfma_f32_16x16x32_bf16 v[80:83], a[8:11], v[184:187], v[80:83]
    ds_read_b64_tr_b16 a[24:25], v4 offset:25536
    v_mfma_f32_16x16x32_bf16 v[112:115], a[8:11], v[188:191], v[112:115]
    ds_read_b64_tr_b16 a[26:27], v4 offset:25792
    v_mfma_f32_16x16x32_bf16 v[144:147], a[8:11], v[192:195], v[144:147]
    ds_read_b64_tr_b16 v[64:65], v12 offset:25376
    s_waitcnt lgkmcnt(7)
    v_mfma_f32_16x16x32_bf16 v[84:87], a[12:15], v[184:187], v[84:87]
    ds_read_b64_tr_b16 a[28:29], v4 offset:25568
    v_mfma_f32_16x16x32_bf16 v[116:119], a[12:15], v[188:191], v[116:119]
    ds_read_b64_tr_b16 a[30:31], v4 offset:25824
    v_mfma_f32_16x16x32_bf16 v[148:151], a[12:15], v[192:195], v[148:151]
    ds_read_b64_tr_b16 v[66:67], v12 offset:25632
    s_add_u32 s79, s79, 1
    v_mfma_f32_16x16x32_bf16 v[88:91], a[16:19], v[184:187], v[88:91]
    v_mov_b32 v70, s79
    ds_write_b32 v69, v70 offset:16
    v_mfma_f32_16x16x32_bf16 v[120:123], a[16:19], v[188:191], v[120:123]
    ds_read_b64_tr_b16 a[0:1], v4 offset:33792
    v_mfma_f32_16x16x32_bf16 v[152:155], a[16:19], v[192:195], v[152:155]
    ds_read_b64_tr_b16 a[2:3], v4 offset:34048
    s_waitcnt lgkmcnt(9)
    v_mfma_f32_16x16x32_bf16 v[92:95], a[20:23], v[184:187], v[92:95]
    ds_read_b64_tr_b16 a[4:5], v4 offset:33824
    v_mfma_f32_16x16x32_bf16 v[124:127], a[20:23], v[188:191], v[124:127]
    ds_read_b64_tr_b16 a[6:7], v4 offset:34080
    v_mfma_f32_16x16x32_bf16 v[156:159], a[20:23], v[192:195], v[156:159]
    v_mfma_f32_16x16x32_bf16 v[52:55], v[60:63], v[196:199], v[52:55]
    s_waitcnt lgkmcnt(5)
    v_mfma_f32_16x16x32_bf16 v[96:99], a[24:27], v[184:187], v[96:99]
    ds_read_b64_tr_b16 a[8:9], v4 offset:33856
    v_mfma_f32_16x16x32_bf16 v[128:131], a[24:27], v[188:191], v[128:131]
    ds_read_b64_tr_b16 a[10:11], v4 offset:34112
    v_mfma_f32_16x16x32_bf16 v[160:163], a[24:27], v[192:195], v[160:163]
    v_mfma_f32_16x16x32_bf16 v[56:59], v[64:67], v[196:199], v[56:59]
    v_mfma_f32_16x16x32_bf16 v[100:103], a[28:31], v[184:187], v[100:103]
    ds_read_b64_tr_b16 a[12:13], v4 offset:33888
    v_mfma_f32_16x16x32_bf16 v[132:135], a[28:31], v[188:191], v[132:135]
    ds_read_b64_tr_b16 a[14:15], v4 offset:34144
    v_mfma_f32_16x16x32_bf16 v[164:167], a[28:31], v[192:195], v[164:167]
    s_waitcnt lgkmcnt(4)
    v_mfma_f32_16x16x32_bf16 v[72:75], a[0:3], v[20:23], v[72:75]
    ds_read_b64_tr_b16 a[16:17], v4 offset:33920
    v_mfma_f32_16x16x32_bf16 v[104:107], a[0:3], v[24:27], v[104:107]
    ds_read_b64_tr_b16 a[18:19], v4 offset:34176
    v_mfma_f32_16x16x32_bf16 v[136:139], a[0:3], v[28:31], v[136:139]
    ds_read_b64_tr_b16 v[60:61], v12 offset:33792
    v_mfma_f32_16x16x32_bf16 v[76:79], a[4:7], v[20:23], v[76:79]
    ds_read_b64_tr_b16 a[20:21], v4 offset:33952
    s_add_u32 s54, s54, 1
    s_cmp_ge_u32 s54, 3
    s_cselect_b32 s56, 0xffff2980, s57
    s_cselect_b32 s54, 0, s54
    v_mfma_f32_16x16x32_bf16 v[108:111], a[4:7], v[24:27], v[108:111]
    ds_read_b64_tr_b16 a[22:23], v4 offset:34208
    v_mfma_f32_16x16x32_bf16 v[140:143], a[4:7], v[28:31], v[140:143]
    ds_read_b64_tr_b16 v[62:63], v12 offset:34048
    s_waitcnt lgkmcnt(6)
    v_mfma_f32_16x16x32_bf16 v[80:83], a[8:11], v[20:23], v[80:83]
    ds_read_b64_tr_b16 a[24:25], v4 offset:33984
    v_mfma_f32_16x16x32_bf16 v[112:115], a[8:11], v[24:27], v[112:115]
    ds_read_b64_tr_b16 a[26:27], v4 offset:34240
    v_mfma_f32_16x16x32_bf16 v[144:147], a[8:11], v[28:31], v[144:147]
    ds_read_b32 v70, v0 offset:4
    ds_read_b64_tr_b16 v[64:65], v12 offset:33824
    v_add_u32 v8, s56, v8
    v_add_u32 v9, s56, v9
    v_mfma_f32_16x16x32_bf16 v[84:87], a[12:15], v[20:23], v[84:87]
    ds_read_b64_tr_b16 a[28:29], v4 offset:34016
    v_mfma_f32_16x16x32_bf16 v[116:119], a[12:15], v[24:27], v[116:119]
    ds_read_b64_tr_b16 a[30:31], v4 offset:34272
    v_mfma_f32_16x16x32_bf16 v[148:151], a[12:15], v[28:31], v[148:151]
    ds_read_b64_tr_b16 v[66:67], v12 offset:34080
    v_add_u32 v10, s56, v10
    v_add_u32 v11, s56, v11
    s_waitcnt lgkmcnt(11)
    v_mfma_f32_16x16x32_bf16 v[88:91], a[16:19], v[20:23], v[88:91]
    s_waitcnt lgkmcnt(4)
    v_cmp_gt_u32 vcc, s52, v70
    s_cbranch_vccnz L_k_spin_cq4
L_k_ret_cq4:
    s_add_u32 s52, s52, 1
    v_mfma_f32_16x16x32_bf16 v[120:123], a[16:19], v[24:27], v[120:123]
    ds_read_b64_tr_b16 a[0:1], v4 offset:42240
    v_mfma_f32_16x16x32_bf16 v[152:155], a[16:19], v[28:31], v[152:155]
    ds_read_b64_tr_b16 a[2:3], v4 offset:42496
    ds_read_b128 v[168:171], v8 offset:0
    ds_read_b128 v[172:175], v9 offset:0
    v_mfma_f32_16x16x32_bf16 v[92:95], a[20:23], v[20:23], v[92:95]
    ds_read_b64_tr_b16 a[4:5], v4 offset:42272
    v_mfma_f32_16x16x32_bf16 v[124:127], a[20:23], v[24:27], v[124:127]
    ds_read_b64_tr_b16 a[6:7], v4 offset:42528
    v_mfma_f32_16x16x32_bf16 v[156:159], a[20:23], v[28:31], v[156:159]
    ds_read_b128 v[176:179], v10 offset:0
    ds_read_b128 v[180:183], v11 offset:0
    v_mfma_f32_16x16x32_bf16 v[52:55], v[60:63], v[32:35], v[52:55]
    v_mfma_f32_16x16x32_bf16 v[96:99], a[24:27], v[20:23], v[96:99]
    ds_read_b64_tr_b16 a[8:9], v4 offset:42304
    v_mfma_f32_16x16x32_bf16 v[128:131], a[24:27], v[24:27], v[128:131]
    ds_read_b64_tr_b16 a[10:11], v4 offset:42560
    v_mfma_f32_16x16x32_bf16 v[160:163], a[24:27], v[28:31], v[160:163]
    ds_read_b128 v[184:187], v8 offset:64
    ds_read_b128 v[188:191], v9 offset:64
    s_waitcnt lgkmcnt(10)
    v_mfma_f32_16x16x32_bf16 v[56:59], v[64:67], v[32:35], v[56:59]
    v_mfma_f32_16x16x32_bf16 v[100:103], a[28:31], v[20:23], v[100:103]
    ds_read_b64_tr_b16 a[12:13], v4 offset:42336
    v_mfma_f32_16x16x32_bf16 v[132:135], a[28:31], v[24:27], v[132:135]
    ds_read_b64_tr_b16 a[14:15], v4 offset:42592
    v_mfma_f32_16x16x32_bf16 v[164:167], a[28:31], v[28:31], v[164:167]
    ds_read_b128 v[192:195], v10 offset:64
    ds_read_b128 v[196:199], v11 offset:64
    s_add_u32 s79, s79, 3
    v_mov_b32 v70, s79
    ds_write_b32 v69, v70 offset:16
    v_mfma_f32_16x16x32_bf16 v[72:75], a[0:3], v[36:39], v[72:75]
    ds_read_b64_tr_b16 a[16:17], v4 offset:42368
    v_mfma_f32_16x16x32_bf16 v[104:107], a[0:3], v[40:43], v[104:107]
    ds_read_b64_tr_b16 a[18:19], v4 offset:42624
    v_mfma_f32_16x16x32_bf16 v[136:139], a[0:3], v[44:47], v[136:139]
    ds_read_b64_tr_b16 v[60:61], v12 offset:42240
    s_waitcnt lgkmcnt(10)
    v_mfma_f32_16x16x32_bf16 v[76:79], a[4:7], v[36:39], v[76:79]
    ds_read_b64_tr_b16 a[20:21], v4 offset:42400
    v_mfma_f32_16x16x32_bf16 v[108:111], a[4:7], v[40:43], v[108:111]
    ds_read_b64_tr_b16 a[22:23], v4 offset:42656
    v_mfma_f32_16x16x32_bf16 v[140:143], a[4:7], v[44:47], v[140:143]
    ds_read_b64_tr_b16 v[62:63], v12 offset:42496
    v_mfma_f32_16x16x32_bf16 v[80:83], a[8:11], v[36:39], v[80:83]
    ds_read_b64_tr_b16 a[24:25], v4 offset:42432
    v_mfma_f32_16x16x32_bf16 v[112:115], a[8:11], v[40:43], v[112:115]
    ds_read_b64_tr_b16 a[26:27], v4 offset:42688
    v_mfma_f32_16x16x32_bf16 v[144:147], a[8:11], v[44:47], v[144:147]
    ds_read_b64_tr_b16 v[64:65], v12 offset:42272
    s_waitcnt lgkmcnt(7)
    v_mfma_f32_16x16x32_bf16 v[84:87], a[12:15], v[36:39], v[84:87]
    ds_read_b64_tr_b16 a[28:29], v4 offset:42464
    v_mfma_f32_16x16x32_bf16 v[116:119], a[12:15], v[40:43], v[116:119]
    ds_read_b64_tr_b16 a[30:31], v4 offset:42720
    v_mfma_f32_16x16x32_bf16 v[148:151], a[12:15], v[44:47], v[148:151]
    ds_read_b64_tr_b16 v[66:67], v12 offset:42528
    s_add_u32 s79, s79, 1
    v_mfma_f32_16x16x32_bf16 v[88:91], a[16:19], v[36:39], v[88:91]
    v_mov_b32 v70, s79
    ds_write_b32 v69, v70 offset:16
    v_mfma_f32_16x16x32_bf16 v[120:123], a[16:19], v[40:43], v[120:123]
    ds_read_b64_tr_b16 a[0:1], v4 offset:50688
    v_mfma_f32_16x16x32_bf16 v[152:155], a[16:19], v[44:47], v[152:155]
    ds_read_b64_tr_b16 a[2:3], v4 offset:50944
    s_waitcnt lgkmcnt(9)
    v_mfma_f32_16x16x32_bf16 v[92:95], a[20:23], v[36:39], v[92:95]
    ds_read_b64_tr_b16 a[4:5], v4 offset:50720
    v_mfma_f32_16x16x32_bf16 v[124:127], a[20:23], v[40:43], v[124:127]
    ds_read_b64_tr_b16 a[6:7], v4 offset:50976
    v_mfma_f32_16x16x32_bf16 v[156:159], a[20:23], v[44:47], v[156:159]
    v_mfma_f32_16x16x32_bf16 v[52:55], v[60:63], v[48:51], v[52:55]
    s_waitcnt lgkmcnt(5)
    v_mfma_f32_16x16x32_bf16 v[96:99], a[24:27], v[36:39], v[96:99]
    ds_read_b64_tr_b16 a[8:9], v4 offset:50752
    v_mfma_f32_16x16x32_bf16 v[128:131], a[24:27], v[40:43], v[128:131]
    ds_read_b64_tr_b16 a[10:11], v4 offset:51008
    v_mfma_f32_16x16x32_bf16 v[160:163], a[24:27], v[44:47], v[160:163]
    v_mfma_f32_16x16x32_bf16 v[56:59], v[64:67], v[48:51], v[56:59]
    v_mfma_f32_16x16x32_bf16 v[100:103], a[28:31], v[36:39], v[100:103]
    ds_read_b64_tr_b16 a[12:13], v4 offset:50784
    v_mfma_f32_16x16x32_bf16 v[132:135], a[28:31], v[40:43], v[132:135]
    ds_read_b64_tr_b16 a[14:15], v4 offset:51040
    v_mfma_f32_16x16x32_bf16 v[164:167], a[28:31], v[44:47], v[164:167]
    s_waitcnt lgkmcnt(4)
    v_mfma_f32_16x16x32_bf16 v[72:75], a[0:3], v[168:171], v[72:75]
    ds_read_b64_tr_b16 a[16:17], v4 offset:50816
    v_mfma_f32_16x16x32_bf16 v[104:107], a[0:3], v[172:175], v[104:107]
    ds_read_b64_tr_b16 a[18:19], v4 offset:51072
    v_mfma_f32_16x16x32_bf16 v[136:139], a[0:3], v[176:179], v[136:139]
    ds_read_b64_tr_b16 v[60:61], v12 offset:50688
    v_mfma_f32_16x16x32_bf16 v[76:79], a[4:7], v[168:171], v[76:79]
    ds_read_b64_tr_b16 a[20:21], v4 offset:50848
    s_add_u32 s54, s54, 1
    s_cmp_ge_u32 s54, 3
    s_cselect_b32 s56, 0xffff2980, s57
    s_cselect_b32 s54, 0, s54
    v_mfma_f32_16x16x32_bf16 v[108:111], a[4:7], v[172:175], v[108:111]
    ds_read_b64_tr_b16 a[22:23], v4 offset:51104
    v_mfma_f32_16x16x32_bf16 v[140:143], a[4:7], v[176:179], v[140:143]
    ds_read_b64_tr_b16 v[62:63], v12 offset:50944
    s_waitcnt lgkmcnt(6)
    v_mfma_f32_16x16x32_bf16 v[80:83], a[8:11], v[168:171], v[80:83]
    ds_read_b64_tr_b16 a[24:25], v4 offset:50880
    v_mfma_f32_16x16x32_bf16 v[112:115], a[8:11], v[172:175], v[112:115]
    ds_read_b64_tr_b16 a[26:27], v4 offset:51136
    v_mfma_f32_16x16x32_bf16 v[144:147], a[8:11], v[176:179], v[144:147]
    ds_read_b32 v70, v0 offset:0
    ds_read_b64_tr_b16 v[64:65], v12 offset:50720
    v_add_u32 v8, s56, v8
    v_add_u32 v9, s56, v9
    v_mfma_f32_16x16x32_bf16 v[84:87], a[12:15], v[168:171], v[84:87]
    ds_read_b64_tr_b16 a[28:29], v4 offset:50912
    v_mfma_f32_16x16x32_bf16 v[116:119], a[12:15], v[172:175], v[116:119]
    ds_read_b64_tr_b16 a[30:31], v4 offset:51168
    v_mfma_f32_16x16x32_bf16 v[148:151], a[12:15], v[176:179], v[148:151]
    ds_read_b64_tr_b16 v[66:67], v12 offset:50976
    v_add_u32 v10, s56, v10
    v_add_u32 v11, s56, v11
    s_waitcnt lgkmcnt(11)
    v_mfma_f32_16x16x32_bf16 v[88:91], a[16:19], v[168:171], v[88:91]
    s_waitcnt lgkmcnt(4)
    v_cmp_gt_u32 vcc, s52, v70
    s_cbranch_vccnz L_k_spin_cq6
L_k_ret_cq6:
    s_add_u32 s52, s52, 1
    v_mfma_f32_16x16x32_bf16 v[120:123], a[16:19], v[172:175], v[120:123]
    ds_read_b64_tr_b16 a[0:1], v4 offset:59136
    v_mfma_f32_16x16x32_bf16 v[152:155], a[16:19], v[176:179], v[152:155]
    ds_read_b64_tr_b16 a[2:3], v4 offset:59392
    ds_read_b128 v[20:23], v8 offset:0
    ds_read_b128 v[24:27], v9 offset:0
    v_mfma_f32_16x16x32_bf16 v[92:95], a[20:23], v[168:171], v[92:95]
    ds_read_b64_tr_b16 a[4:5], v4 offset:59168
    v_mfma_f32_16x16x32_bf16 v[124:127], a[20:23], v[172:175], v[124:127]
    ds_read_b64_tr_b16 a[6:7], v4 offset:59424
    v_mfma_f32_16x16x32_bf16 v[156:159], a[20:23], v[176:179], v[156:159]
    ds_read_b128 v[28:31], v10 offset:0
    ds_read_b128 v[32:35], v11 offset:0
    v_mfma_f32_16x16x32_bf16 v[52:55], v[60:63], v[180:183], v[52:55]
    v_mfma_f32_16x16x32_bf16 v[96:99], a[24:27], v[168:171], v[96:99]
    ds_read_b64_tr_b16 a[8:9], v4 offset:59200
    v_mfma_f32_16x16x32_bf16 v[128:131], a[24:27], v[172:175], v[128:131]
    ds_read_b64_tr_b16 a[10:11], v4 offset:59456
    v_mfma_f32_16x16x32_bf16 v[160:163], a[24:27], v[176:179], v[160:163]
    ds_read_b128 v[36:39], v8 offset:64
    ds_read_b128 v[40:43], v9 offset:64
    s_waitcnt lgkmcnt(10)
    v_mfma_f32_16x16x32_bf16 v[56:59], v[64:67], v[180:183], v[56:59]
    v_mfma_f32_16x16x32_bf16 v[100:103], a[28:31], v[168:171], v[100:103]
    ds_read_b64_tr_b16 a[12:13], v4 offset:59232
    v_mfma_f32_16x16x32_bf16 v[132:135], a[28:31], v[172:175], v[132:135]
    ds_read_b64_tr_b16 a[14:15], v4 offset:59488
    v_mfma_f32_16x16x32_bf16 v[164:167], a[28:31], v[176:179], v[164:167]
    ds_read_b128 v[44:47], v10 offset:64
    ds_read_b128 v[48:51], v11 offset:64
    s_add_u32 s79, s79, 3
    v_mov_b32 v70, s79
    ds_write_b32 v69, v70 offset:16
    v_mfma_f32_16x16x32_bf16 v[72:75], a[0:3], v[184:187], v[72:75]
    ds_read_b64_tr_b16 a[16:17], v4 offset:59264
    v_mfma_f32_16x16x32_bf16 v[104:107], a[0:3], v[188:191], v[104:107]
    ds_read_b64_tr_b16 a[18:19], v4 offset:59520
    v_mfma_f32_16x16x32_bf16 v[136:139], a[0:3], v[192:195], v[136:139]
    ds_read_b64_tr_b16 v[60:61], v12 offset:59136
    s_waitcnt lgkmcnt(10)
    v_mfma_f32_16x16x32_bf16 v[76:79], a[4:7], v[184:187], v[76:79]
    ds_read_b64_tr_b16 a[20:21], v4 offset:59296
    v_mfma_f32_16x16x32_bf16 v[108:111], a[4:7], v[188:191], v[108:111]
    ds_read_b64_tr_b16 a[22:23], v4 offset:59552
    v_mfma_f32_16x16x32_bf16 v[140:143], a[4:7], v[192:195], v[140:143]
    ds_read_b64_tr_b16 v[62:63], v12 offset:59392
    v_mfma_f32_16x16x32_bf16 v[80:83], a[8:11], v[184:187], v[80:83]
    ds_read_b64_tr_b16 a[24:25], v4 offset:59328
    v_mfma_f32_16x16x32_bf16 v[112:115], a[8:11], v[188:191], v[112:115]
    ds_read_b64_tr_b16 a[26:27], v4 offset:59584
    v_mfma_f32_16x16x32_bf16 v[144:147], a[8:11], v[192:195], v[144:147]
    ds_read_b64_tr_b16 v[64:65], v12 offset:59168
    s_waitcnt lgkmcnt(7)
    v_mfma_f32_16x16x32_bf16 v[84:87], a[12:15], v[184:187], v[84:87]
    ds_read_b64_tr_b16 a[28:29], v4 offset:59360
    v_mfma_f32_16x16x32_bf16 v[116:119], a[12:15], v[188:191], v[116:119]
    ds_read_b64_tr_b16 a[30:31], v4 offset:59616
    v_mfma_f32_16x16x32_bf16 v[148:151], a[12:15], v[192:195], v[148:151]
    ds_read_b64_tr_b16 v[66:67], v12 offset:59424
    s_add_u32 s79, s79, 1
    v_mfma_f32_16x16x32_bf16 v[88:91], a[16:19], v[184:187], v[88:91]
    v_mov_b32 v70, s79
    ds_write_b32 v69, v70 offset:16
    v_mfma_f32_16x16x32_bf16 v[120:123], a[16:19], v[188:191], v[120:123]
    ds_read_b64_tr_b16 a[0:1], v4 offset:0
    v_mfma_f32_16x16x32_bf16 v[152:155], a[16:19], v[192:195], v[152:155]
    ds_read_b64_tr_b16 a[2:3], v4 offset:256
    s_waitcnt lgkmcnt(9)
    v_mfma_f32_16x16x32_bf16 v[92:95], a[20:23], v[184:187], v[92:95]
    ds_read_b64_tr_b16 a[4:5], v4 offset:32
    v_mfma_f32_16x16x32_bf16 v[124:127], a[20:23], v[188:191], v[124:127]
    ds_read_b64_tr_b16 a[6:7], v4 offset:288
    v_mfma_f32_16x16x32_bf16 v[156:159], a[20:23], v[192:195], v[156:159]
    v_mfma_f32_16x16x32_bf16 v[52:55], v[60:63], v[196:199], v[52:55]
    s_waitcnt lgkmcnt(5)
    v_mfma_f32_16x16x32_bf16 v[96:99], a[24:27], v[184:187], v[96:99]
    ds_read_b64_tr_b16 a[8:9], v4 offset:64
    v_mfma_f32_16x16x32_bf16 v[128:131], a[24:27], v[188:191], v[128:131]
    ds_read_b64_tr_b16 a[10:11], v4 offset:320
    v_mfma_f32_16x16x32_bf16 v[160:163], a[24:27], v[192:195], v[160:163]
    v_mfma_f32_16x16x32_bf16 v[56:59], v[64:67], v[196:199], v[56:59]
    v_mfma_f32_16x16x32_bf16 v[100:103], a[28:31], v[184:187], v[100:103]
    ds_read_b64_tr_b16 a[12:13], v4 offset:96
    v_mfma_f32_16x16x32_bf16 v[132:135], a[28:31], v[188:191], v[132:135]
    ds_read_b64_tr_b16 a[14:15], v4 offset:352
    v_mfma_f32_16x16x32_bf16 v[164:167], a[28:31], v[192:195], v[164:167]
    s_add_u32 s51, s51, 1
    s_cmp_lt_u32 s51, 2
    s_cbranch_scc1 L_k_cq_loop
    s_mov_b32 s79, 0x3e8
    v_mov_b32 v70, s79
    ds_write_b32 v69, v70 offset:16
    v_pk_mul_f32 v[52:53], v[52:53], s[58:59]
    v_pk_mul_f32 v[54:55], v[54:55], s[58:59]
    v_pk_mul_f32 v[56:57], v[56:57], s[58:59]
    v_pk_mul_f32 v[58:59], v[58:59], s[58:59]
    v_cvt_pk_bf16_f32 v52, v52, v53
    v_cvt_pk_bf16_f32 v53, v54, v55
    v_cvt_pk_bf16_f32 v54, v56, v57
    v_cvt_pk_bf16_f32 v55, v58, v59
    v_pk_mul_f32 v[72:73], v[72:73], s[58:59]
    v_pk_mul_f32 v[74:75], v[74:75], s[58:59]
    v_pk_mul_f32 v[76:77], v[76:77], s[58:59]
    v_pk_mul_f32 v[78:79], v[78:79], s[58:59]
    v_cvt_pk_bf16_f32 v168, v72, v73
    v_cvt_pk_bf16_f32 v169, v74, v75
    v_cvt_pk_bf16_f32 v170, v76, v77
    v_cvt_pk_bf16_f32 v171, v78, v79
    v_pk_mul_f32 v[104:105], v[104:105], s[58:59]
    v_pk_mul_f32 v[106:107], v[106:107], s[58:59]
    v_pk_mul_f32 v[108:109], v[108:109], s[58:59]
    v_pk_mul_f32 v[110:111], v[110:111], s[58:59]
    v_cvt_pk_bf16_f32 v184, v104, v105
    v_cvt_pk_bf16_f32 v185, v106, v107
    v_cvt_pk_bf16_f32 v186, v108, v109
    v_cvt_pk_bf16_f32 v187, v110, v111
    v_pk_mul_f32 v[136:137], v[136:137], s[58:59]
    v_pk_mul_f32 v[138:139], v[138:139], s[58:59]
    v_pk_mul_f32 v[140:141], v[140:141], s[58:59]
    v_pk_mul_f32 v[142:143], v[142:143], s[58:59]
    v_cvt_pk_bf16_f32 v200, v136, v137
    v_cvt_pk_bf16_f32 v201, v138, v139
    v_cvt_pk_bf16_f32 v202, v140, v141
    v_cvt_pk_bf16_f32 v203, v142, v143
    v_pk_mul_f32 v[80:81], v[80:81], s[58:59]
    v_pk_mul_f32 v[82:83], v[82:83], s[58:59]
    v_pk_mul_f32 v[84:85], v[84:85], s[58:59]
    v_pk_mul_f32 v[86:87], v[86:87], s[58:59]
    v_cvt_pk_bf16_f32 v172, v80, v81
    v_cvt_pk_bf16_f32 v173, v82, v83
    v_cvt_pk_bf16_f32 v174, v84, v85
    v_cvt_pk_bf16_f32 v175, v86, v87
    v_pk_mul_f32 v[112:113], v[112:113], s[58:59]
    v_pk_mul_f32 v[114:115], v[114:115], s[58:59]
    v_pk_mul_f32 v[116:117], v[116:117], s[58:59]
    v_pk_mul_f32 v[118:119], v[118:119], s[58:59]
    v_cvt_pk_bf16_f32 v188, v112, v113
    v_cvt_pk_bf16_f32 v189, v114, v115
    v_cvt_pk_bf16_f32 v190, v116, v117
    v_cvt_pk_bf16_f32 v191, v118, v119
    v_pk_mul_f32 v[144:145], v[144:145], s[58:59]
    v_pk_mul_f32 v[146:147], v[146:147], s[58:59]
    v_pk_mul_f32 v[148:149], v[148:149], s[58:59]
    v_pk_mul_f32 v[150:151], v[150:151], s[58:59]
    v_cvt_pk_bf16_f32 v204, v144, v145
    v_cvt_pk_bf16_f32 v205, v146, v147
    v_cvt_pk_bf16_f32 v206, v148, v149
    v_cvt_pk_bf16_f32 v207, v150, v151
    v_pk_mul_f32 v[88:89], v[88:89], s[58:59]
    v_pk_mul_f32 v[90:91], v[90:91], s[58:59]
    v_pk_mul_f32 v[92:93], v[92:93], s[58:59]
    v_pk_mul_f32 v[94:95], v[94:95], s[58:59]
    v_cvt_pk_bf16_f32 v176, v88, v89
    v_cvt_pk_bf16_f32 v177, v90, v91
    v_cvt_pk_bf16_f32 v178, v92, v93
    v_cvt_pk_bf16_f32 v179, v94, v95
    v_pk_mul_f32 v[120:121], v[120:121], s[58:59]
    v_pk_mul_f32 v[122:123], v[122:123], s[58:59]
    v_pk_mul_f32 v[124:125], v[124:125], s[58:59]
    v_pk_mul_f32 v[126:127], v[126:127], s[58:59]
    v_cvt_pk_bf16_f32 v192, v120, v121
    v_cvt_pk_bf16_f32 v193, v122, v123
    v_cvt_pk_bf16_f32 v194, v124, v125
    v_cvt_pk_bf16_f32 v195, v126, v127
    v_pk_mul_f32 v[152:153], v[152:153], s[58:59]
    v_pk_mul_f32 v[154:155], v[154:155], s[58:59]
    v_pk_mul_f32 v[156:157], v[156:157], s[58:59]
    v_pk_mul_f32 v[158:159], v[158:159], s[58:59]
    v_cvt_pk_bf16_f32 v208, v152, v153
    v_cvt_pk_bf16_f32 v209, v154, v155
    v_cvt_pk_bf16_f32 v210, v156, v157
    v_cvt_pk_bf16_f32 v211, v158, v159
    v_pk_mul_f32 v[96:97], v[96:97], s[58:59]
    v_pk_mul_f32 v[98:99], v[98:99], s[58:59]
    v_pk_mul_f32 v[100:101], v[100:101], s[58:59]
    v_pk_mul_f32 v[102:103], v[102:103], s[58:59]
    v_cvt_pk_bf16_f32 v180, v96, v97
    v_cvt_pk_bf16_f32 v181, v98, v99
    v_cvt_pk_bf16_f32 v182, v100, v101
    v_cvt_pk_bf16_f32 v183, v102, v103
    v_pk_mul_f32 v[128:129], v[128:129], s[58:59]
    v_pk_mul_f32 v[130:131], v[130:131], s[58:59]
    v_pk_mul_f32 v[132:133], v[132:133], s[58:59]
    v_pk_mul_f32 v[134:135], v[134:135], s[58:59]
    v_cvt_pk_bf16_f32 v196, v128, v129
    v_cvt_pk_bf16_f32 v197, v130, v131
    v_cvt_pk_bf16_f32 v198, v132, v133
    v_cvt_pk_bf16_f32 v199, v134, v135
    v_pk_mul_f32 v[160:161], v[160:161], s[58:59]
    v_pk_mul_f32 v[162:163], v[162:163], s[58:59]
    v_pk_mul_f32 v[164:165], v[164:165], s[58:59]
    v_pk_mul_f32 v[166:167], v[166:167], s[58:59]
    v_cvt_pk_bf16_f32 v212, v160, v161
    v_cvt_pk_bf16_f32 v213, v162, v163
    v_cvt_pk_bf16_f32 v214, v164, v165
    v_cvt_pk_bf16_f32 v215, v166, v167
    v_permlane32_swap_b32 v52, v54
    v_permlane32_swap_b32 v53, v55
    v_permlane32_swap_b32 v168, v170
    v_permlane32_swap_b32 v169, v171
    v_permlane32_swap_b32 v184, v186
    v_permlane32_swap_b32 v185, v187
    v_permlane32_swap_b32 v200, v202
    v_permlane32_swap_b32 v201, v203
    v_permlane32_swap_b32 v172, v174
    v_permlane32_swap_b32 v173, v175
    v_permlane32_swap_b32 v188, v190
    v_permlane32_swap_b32 v189, v191
    v_permlane32_swap_b32 v204, v206
    v_permlane32_swap_b32 v205, v207
    v_permlane32_swap_b32 v176, v178
    v_permlane32_swap_b32 v177, v179
    v_permlane32_swap_b32 v192, v194
    v_permlane32_swap_b32 v193, v195
    v_permlane32_swap_b32 v208, v210
    v_permlane32_swap_b32 v209, v211
    v_permlane32_swap_b32 v180, v182
    v_permlane32_swap_b32 v181, v183
    v_permlane32_swap_b32 v196, v198
    v_permlane32_swap_b32 v197, v199
    v_permlane32_swap_b32 v212, v214
    v_permlane32_swap_b32 v213, v215
    v_permlane16_swap_b32 v52, v54
    v_permlane16_swap_b32 v53, v55
    v_permlane16_swap_b32 v168, v170
    v_permlane16_swap_b32 v169, v171
    v_permlane16_swap_b32 v184, v186
    v_permlane16_swap_b32 v185, v187
    v_permlane16_swap_b32 v200, v202
    v_permlane16_swap_b32 v201, v203
    v_permlane16_swap_b32 v172, v174
    v_permlane16_swap_b32 v173, v175
    v_permlane16_swap_b32 v188, v190
    v_permlane16_swap_b32 v189, v191
    v_permlane16_swap_b32 v204, v206
    v_permlane16_swap_b32 v205, v207
    v_permlane16_swap_b32 v176, v178
    v_permlane16_swap_b32 v177, v179
    v_permlane16_swap_b32 v192, v194
    v_permlane16_swap_b32 v193, v195
    v_permlane16_swap_b32 v208, v210
    v_permlane16_swap_b32 v209, v211
    v_permlane16_swap_b32 v180, v182
    v_permlane16_swap_b32 v181, v183
    v_permlane16_swap_b32 v196, v198
    v_permlane16_swap_b32 v197, v199
    v_permlane16_swap_b32 v212, v214
    v_permlane16_swap_b32 v213, v215
    v_lshlrev_b32 v5, 4, v1
    s_lshl_b32 s47, s44, 10
    s_add_u32 s47, s47, 0x26380
    v_add_u32 v5, s47, v5
    ds_write_b128 v5, v[52:55]
    s_mov_b32 s79, 0x3e9
    v_mov_b32 v70, s79
    ds_write_b32 v69, v70 offset:16
    v_add_u32 v3, 0x4200, v3
    s_mov_b32 s54, 0
    s_mov_b32 s55, 1
    s_mov_b32 s56, 0
    s_mov_b32 s51, 0
    s_mov_b32 s79, 0
    s_mov_b32 s52, 2
    s_mov_b32 s53, 3
L_k_poll_k0:
    ds_read_b64 v[70:71], v0 offset:8
    s_waitcnt lgkmcnt(0)
    v_min_u32 v70, v70, v71
    v_cmp_gt_u32 vcc, 1, v70
    s_cbranch_vccz L_k_pok_k0
    s_sleep 1
    s_sub_u32 s80, s80, 1
    s_cbranch_scc0 L_k_poll_k0
    s_endpgm
L_k_pok_k0:
    ds_read_b128 a[16:19], v2 offset:0
    ds_read_b128 a[20:23], v2 offset:64
    ds_read_b128 a[24:27], v2 offset:128
    ds_read_b128 a[28:31], v2 offset:192
    ds_read_b128 a[32:35], v2 offset:512
    ds_read_b128 a[36:39], v2 offset:576
    ds_read_b128 a[0:3], v2 offset:640
    ds_read_b128 a[4:7], v2 offset:704
    s_waitcnt lgkmcnt(7)
    v_mfma_f32_16x16x32_bf16 v[20:23], a[16:19], v[168:171], 0
    v_mov_b32 v72, 0
    v_mov_b32 v73, 0
    v_mov_b32 v74, 0
    v_mfma_f32_16x16x32_bf16 v[24:27], a[16:19], v[184:187], 0
    v_mov_b32 v75, 0
    v_mov_b32 v76, 0
    v_mov_b32 v77, 0
    v_mfma_f32_16x16x32_bf16 v[28:31], a[16:19], v[200:203], 0
    v_mov_b32 v78, 0
    v_mov_b32 v79, 0
    v_mov_b32 v80, 0
    s_waitcnt lgkmcnt(6)
    v_mfma_f32_16x16x32_bf16 v[20:23], a[20:23], v[172:175], v[20:23]
    v_mov_b32 v81, 0
    v_mov_b32 v82, 0
    v_mov_b32 v83, 0
    v_mfma_f32_16x16x32_bf16 v[24:27], a[20:23], v[188:191], v[24:27]
    v_mov_b32 v84, 0
    v_mov_b32 v85, 0
    v_mov_b32 v86, 0
    v_mfma_f32_16x16x32_bf16 v[28:31], a[20:23], v[204:207], v[28:31]
    v_mov_b32 v87, 0
    v_mov_b32 v88, 0
    v_mov_b32 v89, 0
    s_waitcnt lgkmcnt(5)
    v_mfma_f32_16x16x32_bf16 v[20:23], a[24:27], v[176:179], v[20:23]
    v_mov_b32 v90, 0
    v_mov_b32 v91, 0
    v_mov_b32 v92, 0
    v_mfma_f32_16x16x32_bf16 v[24:27], a[24:27], v[192:195], v[24:27]
    v_mov_b32 v93, 0
    v_mov_b32 v94, 0
    v_mov_b32 v95, 0
    v_mfma_f32_16x16x32_bf16 v[28:31], a[24:27], v[208:211], v[28:31]
    v_mov_b32 v96, 0
    v_mov_b32 v97, 0
    v_mov_b32 v98, 0
    s_waitcnt lgkmcnt(4)
    v_mfma_f32_16x16x32_bf16 v[20:23], a[28:31], v[180:183], v[20:23]
    v_mov_b32 v99, 0
    v_mov_b32 v100, 0
    v_mov_b32 v101, 0
    v_mfma_f32_16x16x32_bf16 v[24:27], a[28:31], v[196:199], v[24:27]
    v_mov_b32 v102, 0
    v_mov_b32 v103, 0
    v_mov_b32 v104, 0
    v_mfma_f32_16x16x32_bf16 v[28:31], a[28:31], v[212:215], v[28:31]
    v_mov_b32 v105, 0
    v_mov_b32 v106, 0
    v_mov_b32 v107, 0
    s_waitcnt lgkmcnt(3)
    v_mfma_f32_16x16x32_bf16 v[32:35], a[32:35], v[168:171], 0
    v_mov_b32 v108, 0
    v_mov_b32 v109, 0
    v_mov_b32 v110, 0
    v_mfma_f32_16x16x32_bf16 v[36:39], a[32:35], v[184:187], 0
    v_mov_b32 v111, 0
    v_mov_b32 v112, 0
    v_mov_b32 v113, 0
    v_mfma_f32_16x16x32_bf16 v[40:43], a[32:35], v[200:203], 0
    v_mov_b32 v114, 0
    v_mov_b32 v115, 0
    v_mov_b32 v116, 0
    s_waitcnt lgkmcnt(2)
    v_mfma_f32_16x16x32_bf16 v[32:35], a[36:39], v[172:175], v[32:35]
    v_mov_b32 v117, 0
    v_mov_b32 v118, 0
    v_mov_b32 v119, 0
    v_mfma_f32_16x16x32_bf16 v[36:39], a[36:39], v[188:191], v[36:39]
    v_mov_b32 v120, 0
    v_mov_b32 v121, 0
    v_mov_b32 v122, 0
    v_mfma_f32_16x16x32_bf16 v[40:43], a[36:39], v[204:207], v[40:43]
    v_mov_b32 v123, 0
    v_mov_b32 v124, 0
    v_mov_b32 v125, 0
    s_waitcnt lgkmcnt(1)
    v_mfma_f32_16x16x32_bf16 v[32:35], a[0:3], v[176:179], v[32:35]
    v_mov_b32 v126, 0
    v_mov_b32 v127, 0
    v_mov_b32 v128, 0
    v_mfma_f32_16x16x32_bf16 v[36:39], a[0:3], v[192:195], v[36:39]
    v_mov_b32 v129, 0
    v_mov_b32 v130, 0
    v_mov_b32 v131, 0
    v_mfma_f32_16x16x32_bf16 v[40:43], a[0:3], v[208:211], v[40:43]
    v_mov_b32 v132, 0
    v_mov_b32 v133, 0
    v_mov_b32 v134, 0
    s_waitcnt lgkmcnt(0)
    v_mfma_f32_16x16x32_bf16 v[32:35], a[4:7], v[180:183], v[32:35]
    v_mov_b32 v135, 0
    v_mov_b32 v136, 0
    v_mov_b32 v137, 0
    v_mfma_f32_16x16x32_bf16 v[36:39], a[4:7], v[196:199], v[36:39]
    v_mov_b32 v138, 0
    v_mov_b32 v139, 0
    v_mov_b32 v140, 0
    v_mfma_f32_16x16x32_bf16 v[40:43], a[4:7], v[212:215], v[40:43]
    v_mov_b32 v141, 0
    v_mov_b32 v142, 0
    v_mov_b32 v143, 0
    v_mov_b32 v144, 0
    v_mov_b32 v145, 0
    v_mov_b32 v146, 0
    v_mov_b32 v147, 0
    v_mov_b32 v148, 0
    v_mov_b32 v149, 0
    v_mov_b32 v150, 0
    v_mov_b32 v151, 0
    v_mov_b32 v152, 0
    v_mov_b32 v153, 0
    v_mov_b32 v154, 0
    v_mov_b32 v155, 0
    v_mov_b32 v156, 0
    v_mov_b32 v157, 0
    v_mov_b32 v158, 0
    v_mov_b32 v159, 0
    v_mov_b32 v160, 0
    v_mov_b32 v161, 0
    v_mov_b32 v162, 0
    v_mov_b32 v163, 0
    v_mov_b32 v164, 0
    v_mov_b32 v165, 0
    v_mov_b32 v166, 0
    v_mov_b32 v167, 0
    v_mov_b32 v68, 0x3f803f80
    v_accvgpr_write_b32 a0, 0
    v_accvgpr_write_b32 a1, 0
    v_accvgpr_write_b32 a2, 0
    v_accvgpr_write_b32 a3, 0
    v_accvgpr_write_b32 a4, 0
    v_accvgpr_write_b32 a5, 0
    v_accvgpr_write_b32 a6, 0
    v_accvgpr_write_b32 a7, 0
    v_accvgpr_write_b32 a8, 0
    v_accvgpr_write_b32 a9, 0
    v_accvgpr_write_b32 a10, 0
    v_accvgpr_write_b32 a11, 0
    v_accvgpr_write_b32 a12, v68
    v_accvgpr_write_b32 a13, v68
    v_accvgpr_write_b32 a14, v68
    v_accvgpr_write_b32 a15, v68
    v_max3_f32 v5, v20, v21, v22
    v_max3_f32 v5, v5, v23, v32
    v_max3_f32 v5, v5, v33, v34
    v_max_f32 v5, v5, v35
    v_mov_b32 v6, v5
    v_mov_b32 v7, v5
    s_nop 1
    v_permlane32_swap_b32 v6, v7
    v_max_f32 v5, v6, v7
    v_mov_b32 v6, v5
    v_mov_b32 v7, v5
    s_nop 1
    v_permlane16_swap_b32 v6, v7
    v_max_f32 v5, v6, v7
    v_sub_f32 v8, 0xc0e00000, v5
    v_mov_b32 v9, v8
    v_mov_b32 v10, v8
    v_mov_b32 v11, v8
    v_add_f32 v20, v20, v8
    v_add_f32 v21, v21, v8
    v_add_f32 v22, v22, v8
    v_add_f32 v23, v23, v8
    v_add_f32 v32, v32, v8
    v_add_f32 v33, v33, v8
    v_add_f32 v34, v34, v8
    v_add_f32 v35, v35, v8
    v_max3_f32 v5, v24, v25, v26
    v_max3_f32 v5, v5, v27, v36
    v_max3_f32 v5, v5, v37, v38
    v_max_f32 v5, v5, v39
    v_mov_b32 v6, v5
    v_mov_b32 v7, v5
    s_nop 1
    v_permlane32_swap_b32 v6, v7
    v_max_f32 v5, v6, v7
    v_mov_b32 v6, v5
    v_mov_b32 v7, v5
    s_nop 1
    v_permlane16_swap_b32 v6, v7
    v_max_f32 v5, v6, v7
    v_sub_f32 v12, 0xc0e00000, v5
    v_mov_b32 v13, v12
    v_mov_b32 v14, v12
    v_mov_b32 v15, v12
    v_add_f32 v24, v24, v12
    v_add_f32 v25, v25, v12
    v_add_f32 v26, v26, v12
    v_add_f32 v27, v27, v12
    v_add_f32 v36, v36, v12
    v_add_f32 v37, v37, v12
    v_add_f32 v38, v38, v12
    v_add_f32 v39, v39, v12
    v_max3_f32 v5, v28, v29, v30
    v_max3_f32 v5, v5, v31, v40
    v_max3_f32 v5, v5, v41, v42
    v_max_f32 v5, v5, v43
    v_mov_b32 v6, v5
    v_mov_b32 v7, v5
    s_nop 1
    v_permlane32_swap_b32 v6, v7
    v_max_f32 v5, v6, v7
    v_mov_b32 v6, v5
    v_mov_b32 v7, v5
    s_nop 1
    v_permlane16_swap_b32 v6, v7
    v_max_f32 v5, v6, v7
    v_sub_f32 v16, 0xc0e00000, v5
    v_mov_b32 v17, v16
    v_mov_b32 v18, v16
    v_mov_b32 v19, v16
    v_add_f32 v28, v28, v16
    v_add_f32 v29, v29, v16
    v_add_f32 v30, v30, v16
    v_add_f32 v31, v31, v16
    v_add_f32 v40, v40, v16
    v_add_f32 v41, v41, v16
    v_add_f32 v42, v42, v16
    v_add_f32 v43, v43, v16
    ds_read_b128 a[16:19], v2 offset:8448
    ds_read_b128 a[20:23], v2 offset:8512
    ds_read_b128 a[24:27], v2 offset:8576
    ds_read_b128 a[28:31], v2 offset:8640
    v_exp_f32 v20, v20
    v_exp_f32 v21, v21
    v_exp_f32 v22, v22
    v_exp_f32 v23, v23
    v_exp_f32 v24, v24
    v_exp_f32 v25, v25
    v_exp_f32 v26, v26
    v_exp_f32 v27, v27
    v_exp_f32 v28, v28
    v_exp_f32 v29, v29
    v_exp_f32 v30, v30
    v_exp_f32 v31, v31
    v_exp_f32 v32, v32
    v_exp_f32 v33, v33
    v_exp_f32 v34, v34
    v_exp_f32 v35, v35
    v_exp_f32 v36, v36
    v_exp_f32 v37, v37
L_k_c_loop:
    s_waitcnt lgkmcnt(2)
    v_mfma_f32_16x16x32_bf16 v[44:47], a[16:19], v[168:171], v[8:11]
    ds_read_b128 a[32:35], v2 offset:8960
    v_cvt_pk_bf16_f32 v20, v20, v21
    v_mfma_f32_16x16x32_bf16 v[48:51], a[16:19], v[184:187], v[12:15]
    v_exp_f32 v38, v38
    v_mfma_f32_16x16x32_bf16 v[52:55], a[16:19], v[200:203], v[16:19]
    v_exp_f32 v39, v39
    v_mfma_f32_16x16x32_bf16 v[44:47], a[20:23], v[172:175], v[44:47]
    ds_read_b128 a[36:39], v2 offset:9024
    v_cvt_pk_bf16_f32 v21, v22, v23
    v_mfma_f32_16x16x32_bf16 v[48:51], a[20:23], v[188:191], v[48:51]
    ds_read_b64 v[70:71], v0 offset:8
    v_cvt_pk_bf16_f32 v22, v32, v33
    v_mfma_f32_16x16x32_bf16 v[52:55], a[20:23], v[204:207], v[52:55]
    v_exp_f32 v40, v40
    s_waitcnt lgkmcnt(3)
    v_mfma_f32_16x16x32_bf16 v[44:47], a[24:27], v[176:179], v[44:47]
    ds_read_b128 a[16:19], v2 offset:9088
    v_cvt_pk_bf16_f32 v23, v34, v35
    v_mfma_f32_16x16x32_bf16 v[48:51], a[24:27], v[192:195], v[48:51]
    v_exp_f32 v41, v41
    v_mfma_f32_16x16x32_bf16 v[52:55], a[24:27], v[208:211], v[52:55]
    v_exp_f32 v42, v42
    v_mfma_f32_16x16x32_bf16 v[44:47], a[28:31], v[180:183], v[44:47]
    ds_read_b128 a[20:23], v2 offset:9152
    v_or3_b32 v4, v20, v21, v22
    v_mfma_f32_16x16x32_bf16 v[48:51], a[28:31], v[196:199], v[48:51]
    v_exp_f32 v43, v43
    v_mfma_f32_16x16x32_bf16 v[52:55], a[28:31], v[212:215], v[52:55]
    v_cvt_pk_bf16_f32 v24, v24, v25
    v_cvt_pk_bf16_f32 v25, v26, v27
    s_waitcnt lgkmcnt(4)
    v_mfma_f32_16x16x32_bf16 v[56:59], a[32:35], v[168:171], v[8:11]
    s_waitcnt lgkmcnt(2)
    v_min_u32 v70, v70, v71
    v_cmp_gt_u32 vcc, s52, v70
    s_cbranch_vccnz L_k_spin_cv
L_k_ret_cv:
    ds_read_b64_tr_b16 a[24:25], v3 offset:0
    v_mfma_f32_16x16x32_bf16 v[60:63], a[32:35], v[184:187], v[12:15]
    ds_read_b64_tr_b16 a[26:27], v3 offset:512
    v_cvt_pk_bf16_f32 v26, v36, v37
    v_mfma_f32_16x16x32_bf16 v[64:67], a[32:35], v[200:203], v[16:19]
    v_cvt_pk_bf16_f32 v27, v38, v39
    v_or3_b32 v4, v4, v23, v24
    v_mfma_f32_16x16x32_bf16 v[56:59], a[36:39], v[172:175], v[56:59]
    ds_read_b64_tr_b16 a[28:29], v3 offset:32
    v_or3_b32 v4, v4, v25, v26
    v_mfma_f32_16x16x32_bf16 v[60:63], a[36:39], v[188:191], v[60:63]
    ds_read_b64_tr_b16 a[30:31], v3 offset:544
    v_cvt_pk_bf16_f32 v28, v28, v29
    v_mfma_f32_16x16x32_bf16 v[64:67], a[36:39], v[204:207], v[64:67]
    v_cvt_pk_bf16_f32 v29, v30, v31
    v_cvt_pk_bf16_f32 v30, v40, v41
    s_waitcnt lgkmcnt(4)
    v_mfma_f32_16x16x32_bf16 v[56:59], a[16:19], v[176:179], v[56:59]
    ds_read_b64_tr_b16 a[32:33], v3 offset:64
    v_cvt_pk_bf16_f32 v31, v42, v43
    v_mfma_f32_16x16x32_bf16 v[60:63], a[16:19], v[192:195], v[60:63]
    ds_read_b64_tr_b16 a[34:35], v3 offset:576
    v_or3_b32 v4, v4, v27, v28
    v_mfma_f32_16x16x32_bf16 v[64:67], a[16:19], v[208:211], v[64:67]
    v_or3_b32 v4, v4, v29, v30
    v_or_b32 v4, v4, v31
    v_mfma_f32_16x16x32_bf16 v[56:59], a[20:23], v[180:183], v[56:59]
    ds_read_b64_tr_b16 a[36:37], v3 offset:96
    v_and_b32 v4, 0x40004000, v4
    v_mfma_f32_16x16x32_bf16 v[60:63], a[20:23], v[196:199], v[60:63]
    ds_read_b64_tr_b16 a[38:39], v3 offset:608
    v_mfma_f32_16x16x32_bf16 v[64:67], a[20:23], v[212:215], v[64:67]
    v_cmp_ne_u32 vcc, 0, v4
    s_cbranch_vccnz L_k_c_rare0
L_k_c_ret0:
    v_mfma_f32_16x16x32_bf16 a[0:3], a[12:15], v[20:23], a[0:3]
    s_add_u32 s54, s54, 2
    s_cmp_ge_u32 s54, 9
    s_cselect_b32 s56, 0xfffe3200, s77
    s_cselect_b32 s47, 9, 0
    s_sub_u32 s54, s54, s47
    v_exp_f32 v44, v44
    v_mfma_f32_16x16x32_bf16 a[4:7], a[12:15], v[24:27], a[4:7]
    v_exp_f32 v45, v45
    v_mfma_f32_16x16x32_bf16 a[8:11], a[12:15], v[28:31], a[8:11]
    v_add_u32 v2, s56, v2
    s_waitcnt lgkmcnt(4)
    v_mfma_f32_16x16x32_bf16 v[72:75], a[24:27], v[20:23], v[72:75]
    ds_read_b64_tr_b16 a[16:17], v3 offset:128
    v_mfma_f32_16x16x32_bf16 v[104:107], a[24:27], v[24:27], v[104:107]
    ds_read_b64_tr_b16 a[18:19], v3 offset:640
    v_mfma_f32_16x16x32_bf16 v[136:139], a[24:27], v[28:31], v[136:139]
    ds_read_b64 v[70:71], v0 offset:8
    v_mfma_f32_16x16x32_bf16 v[76:79], a[28:31], v[20:23], v[76:79]
    ds_read_b64_tr_b16 a[20:21], v3 offset:160
    v_mfma_f32_16x16x32_bf16 v[108:111], a[28:31], v[24:27], v[108:111]
    ds_read_b64_tr_b16 a[22:23], v3 offset:672
    v_mfma_f32_16x16x32_bf16 v[140:143], a[28:31], v[28:31], v[140:143]
    v_exp_f32 v46, v46
    s_waitcnt lgkmcnt(5)
    v_mfma_f32_16x16x32_bf16 v[80:83], a[32:35], v[20:23], v[80:83]
    ds_read_b64_tr_b16 a[24:25], v3 offset:192
    v_mfma_f32_16x16x32_bf16 v[112:115], a[32:35], v[24:27], v[112:115]
    ds_read_b64_tr_b16 a[26:27], v3 offset:704
    v_mfma_f32_16x16x32_bf16 v[144:147], a[32:35], v[28:31], v[144:147]
    v_exp_f32 v47, v47
    v_mfma_f32_16x16x32_bf16 v[84:87], a[36:39], v[20:23], v[84:87]
    ds_read_b64_tr_b16 a[28:29], v3 offset:224
    v_mfma_f32_16x16x32_bf16 v[116:119], a[36:39], v[24:27], v[116:119]
    ds_read_b64_tr_b16 a[30:31], v3 offset:736
    v_mfma_f32_16x16x32_bf16 v[148:151], a[36:39], v[28:31], v[148:151]
    v_exp_f32 v48, v48
    s_waitcnt lgkmcnt(7)
    v_mfma_f32_16x16x32_bf16 v[88:91], a[16:19], v[20:23], v[88:91]
    s_waitcnt lgkmcnt(6)
    v_min_u32 v70, v70, v71
    v_cmp_gt_u32 vcc, s53, v70
    s_cbranch_vccnz L_k_spin_ck
L_k_ret_ck:
    ds_read_b128 a[32:35], v2 offset:0
    v_mfma_f32_16x16x32_bf16 v[120:123], a[16:19], v[24:27], v[120:123]
    v_exp_f32 v49, v49
    v_mfma_f32_16x16x32_bf16 v[152:155], a[16:19], v[28:31], v[152:155]
    v_exp_f32 v50, v50
    s_waitcnt lgkmcnt(3)
    v_mfma_f32_16x16x32_bf16 v[92:95], a[20:23], v[20:23], v[92:95]
    ds_read_b128 a[16:19], v2 offset:64
    v_mfma_f32_16x16x32_bf16 v[124:127], a[20:23], v[24:27], v[124:127]
    v_exp_f32 v51, v51
    v_mfma_f32_16x16x32_bf16 v[156:159], a[20:23], v[28:31], v[156:159]
    v_exp_f32 v52, v52
    v_mfma_f32_16x16x32_bf16 v[96:99], a[24:27], v[20:23], v[96:99]
    ds_read_b128 a[20:23], v2 offset:128
    v_mfma_f32_16x16x32_bf16 v[128:131], a[24:27], v[24:27], v[128:131]
    v_exp_f32 v53, v53
    v_mfma_f32_16x16x32_bf16 v[160:163], a[24:27], v[28:31], v[160:163]
    v_exp_f32 v54, v54
    s_waitcnt lgkmcnt(2)
    v_mfma_f32_16x16x32_bf16 v[100:103], a[28:31], v[20:23], v[100:103]
    ds_read_b128 a[24:27], v2 offset:192
    v_mfma_f32_16x16x32_bf16 v[132:135], a[28:31], v[24:27], v[132:135]
    v_exp_f32 v55, v55
    v_mfma_f32_16x16x32_bf16 v[164:167], a[28:31], v[28:31], v[164:167]
    v_exp_f32 v56, v56
    v_exp_f32 v57, v57
    v_exp_f32 v58, v58
    v_exp_f32 v59, v59
    v_exp_f32 v60, v60
    v_exp_f32 v61, v61
    v_mfma_f32_16x16x32_bf16 v[20:23], a[32:35], v[168:171], v[8:11]
    ds_read_b128 a[28:31], v2 offset:512
    v_cvt_pk_bf16_f32 v44, v44, v45
    v_mfma_f32_16x16x32_bf16 v[24:27], a[32:35], v[184:187], v[12:15]
    v_exp_f32 v62, v62
    v_mfma_f32_16x16x32_bf16 v[28:31], a[32:35], v[200:203], v[16:19]
    v_exp_f32 v63, v63
    s_waitcnt lgkmcnt(2)
    v_mfma_f32_16x16x32_bf16 v[20:23], a[16:19], v[172:175], v[20:23]
    ds_read_b128 a[32:35], v2 offset:576
    v_cvt_pk_bf16_f32 v45, v46, v47
    v_mfma_f32_16x16x32_bf16 v[24:27], a[16:19], v[188:191], v[24:27]
    v_exp_f32 v64, v64
    v_mfma_f32_16x16x32_bf16 v[28:31], a[16:19], v[204:207], v[28:31]
    v_exp_f32 v65, v65
    v_mfma_f32_16x16x32_bf16 v[20:23], a[20:23], v[176:179], v[20:23]
    ds_read_b128 a[16:19], v2 offset:640
    v_cvt_pk_bf16_f32 v46, v56, v57
    v_mfma_f32_16x16x32_bf16 v[24:27], a[20:23], v[192:195], v[24:27]
    v_exp_f32 v66, v66
    v_mfma_f32_16x16x32_bf16 v[28:31], a[20:23], v[208:211], v[28:31]
    v_exp_f32 v67, v67
    s_waitcnt lgkmcnt(2)
    v_mfma_f32_16x16x32_bf16 v[20:23], a[24:27], v[180:183], v[20:23]
    ds_read_b128 a[20:23], v2 offset:704
    v_cvt_pk_bf16_f32 v47, v58, v59
    v_mfma_f32_16x16x32_bf16 v[24:27], a[24:27], v[196:199], v[24:27]
    v_or3_b32 v4, v44, v45, v46
    v_cvt_pk_bf16_f32 v48, v48, v49
    v_mfma_f32_16x16x32_bf16 v[28:31], a[24:27], v[212:215], v[28:31]
    v_cvt_pk_bf16_f32 v49, v50, v51
    v_cvt_pk_bf16_f32 v50, v60, v61
    v_mfma_f32_16x16x32_bf16 v[32:35], a[28:31], v[168:171], v[8:11]
    ds_read_b64_tr_b16 a[24:25], v3 offset:8448
    v_cvt_pk_bf16_f32 v51, v62, v63
    v_mfma_f32_16x16x32_bf16 v[36:39], a[28:31], v[184:187], v[12:15]
    ds_read_b64_tr_b16 a[26:27], v3 offset:8960
    v_or3_b32 v4, v4, v47, v48
    v_mfma_f32_16x16x32_bf16 v[40:43], a[28:31], v[200:203], v[16:19]
    v_or3_b32 v4, v4, v49, v50
    v_cvt_pk_bf16_f32 v52, v52, v53
    s_waitcnt lgkmcnt(3)
    v_mfma_f32_16x16x32_bf16 v[32:35], a[32:35], v[172:175], v[32:35]
    ds_read_b64_tr_b16 a[28:29], v3 offset:8480
    v_cvt_pk_bf16_f32 v53, v54, v55
    v_mfma_f32_16x16x32_bf16 v[36:39], a[32:35], v[188:191], v[36:39]
    ds_read_b64_tr_b16 a[30:31], v3 offset:8992
    v_cvt_pk_bf16_f32 v54, v64, v65
    v_mfma_f32_16x16x32_bf16 v[40:43], a[32:35], v[204:207], v[40:43]
    v_cvt_pk_bf16_f32 v55, v66, v67
    v_or3_b32 v4, v4, v51, v52
    v_mfma_f32_16x16x32_bf16 v[32:35], a[16:19], v[176:179], v[32:35]
    ds_read_b64_tr_b16 a[32:33], v3 offset:8512
    v_or3_b32 v4, v4, v53, v54
    v_mfma_f32_16x16x32_bf16 v[36:39], a[16:19], v[192:195], v[36:39]
    ds_read_b64_tr_b16 a[34:35], v3 offset:9024
    v_or_b32 v4, v4, v55
    v_mfma_f32_16x16x32_bf16 v[40:43], a[16:19], v[208:211], v[40:43]
    v_and_b32 v4, 0x40004000, v4
    s_waitcnt lgkmcnt(6)
    v_mfma_f32_16x16x32_bf16 v[32:35], a[20:23], v[180:183], v[32:35]
    ds_read_b64_tr_b16 a[16:17], v3 offset:8544
    v_mfma_f32_16x16x32_bf16 v[36:39], a[20:23], v[196:199], v[36:39]
    ds_read_b64_tr_b16 a[18:19], v3 offset:9056
    v_mfma_f32_16x16x32_bf16 v[40:43], a[20:23], v[212:215], v[40:43]
    v_cmp_ne_u32 vcc, 0, v4
    s_cbranch_vccnz L_k_c_rare1
L_k_c_ret1:
    v_mfma_f32_16x16x32_bf16 a[0:3], a[12:15], v[44:47], a[0:3]
    v_exp_f32 v20, v20
    v_mfma_f32_16x16x32_bf16 a[4:7], a[12:15], v[48:51], a[4:7]
    v_exp_f32 v21, v21
    v_mfma_f32_16x16x32_bf16 a[8:11], a[12:15], v[52:55], a[8:11]
    v_exp_f32 v22, v22
    s_waitcnt lgkmcnt(4)
    v_mfma_f32_16x16x32_bf16 v[72:75], a[24:27], v[44:47], v[72:75]
    ds_read_b64_tr_b16 a[20:21], v3 offset:8576
    v_mfma_f32_16x16x32_bf16 v[104:107], a[24:27], v[48:51], v[104:107]
    ds_read_b64_tr_b16 a[22:23], v3 offset:9088
    v_mfma_f32_16x16x32_bf16 v[136:139], a[24:27], v[52:55], v[136:139]
    v_exp_f32 v23, v23
    v_mfma_f32_16x16x32_bf16 v[76:79], a[28:31], v[44:47], v[76:79]
    ds_read_b64_tr_b16 a[24:25], v3 offset:8608
    v_mfma_f32_16x16x32_bf16 v[108:111], a[28:31], v[48:51], v[108:111]
    ds_read_b64_tr_b16 a[26:27], v3 offset:9120
    v_mfma_f32_16x16x32_bf16 v[140:143], a[28:31], v[52:55], v[140:143]
    v_exp_f32 v24, v24
    s_waitcnt lgkmcnt(4)
    v_mfma_f32_16x16x32_bf16 v[80:83], a[32:35], v[44:47], v[80:83]
    ds_read_b64_tr_b16 a[28:29], v3 offset:8640
    v_mfma_f32_16x16x32_bf16 v[112:115], a[32:35], v[48:51], v[112:115]
    ds_read_b64_tr_b16 a[30:31], v3 offset:9152
    v_mfma_f32_16x16x32_bf16 v[144:147], a[32:35], v[52:55], v[144:147]
    v_exp_f32 v25, v25
    v_mfma_f32_16x16x32_bf16 v[84:87], a[16:19], v[44:47], v[84:87]
    ds_read_b64_tr_b16 a[32:33], v3 offset:8672
    v_mfma_f32_16x16x32_bf16 v[116:119], a[16:19], v[48:51], v[116:119]
    ds_read_b64_tr_b16 a[34:35], v3 offset:9184
    v_mfma_f32_16x16x32_bf16 v[148:151], a[16:19], v[52:55], v[148:151]
    v_exp_f32 v26, v26
    s_waitcnt lgkmcnt(4)
    v_mfma_f32_16x16x32_bf16 v[88:91], a[20:23], v[44:47], v[88:91]
    ds_read_b128 a[16:19], v2 offset:8448
    v_mfma_f32_16x16x32_bf16 v[120:123], a[20:23], v[48:51], v[120:123]
    s_add_u32 s55, s55, 2
    s_cmp_ge_u32 s55, 9
    s_cselect_b32 s57, 0xfffe3200, s77
    s_cselect_b32 s47, 9, 0
    s_sub_u32 s55, s55, s47
    s_add_u32 s52, s52, 2
    s_add_u32 s53, s53, 2
    s_min_u32 s53, s53, 16
    s_add_u32 s79, s79, 2
    v_exp_f32 v27, v27
    v_mfma_f32_16x16x32_bf16 v[152:155], a[20:23], v[52:55], v[152:155]
    v_mov_b32 v70, s79
    ds_write_b32 v69, v70 offset:32
    v_mfma_f32_16x16x32_bf16 v[92:95], a[24:27], v[44:47], v[92:95]
    ds_read_b128 a[20:23], v2 offset:8512
    v_mfma_f32_16x16x32_bf16 v[124:127], a[24:27], v[48:51], v[124:127]
    v_exp_f32 v28, v28
    v_mfma_f32_16x16x32_bf16 v[156:159], a[24:27], v[52:55], v[156:159]
    v_add_u32 v3, s57, v3
    s_waitcnt lgkmcnt(3)
    v_mfma_f32_16x16x32_bf16 v[96:99], a[28:31], v[44:47], v[96:99]
    ds_read_b128 a[24:27], v2 offset:8576
    v_mfma_f32_16x16x32_bf16 v[128:131], a[28:31], v[48:51], v[128:131]
    v_exp_f32 v29, v29
    v_mfma_f32_16x16x32_bf16 v[160:163], a[28:31], v[52:55], v[160:163]
    v_exp_f32 v30, v30
    v_mfma_f32_16x16x32_bf16 v[100:103], a[32:35], v[44:47], v[100:103]
    ds_read_b128 a[28:31], v2 offset:8640
    v_mfma_f32_16x16x32_bf16 v[132:135], a[32:35], v[48:51], v[132:135]
    v_exp_f32 v31, v31
    v_mfma_f32_16x16x32_bf16 v[164:167], a[32:35], v[52:55], v[164:167]
    v_exp_f32 v32, v32
    v_exp_f32 v33, v33
    v_exp_f32 v34, v34
    v_exp_f32 v35, v35
    v_exp_f32 v36, v36
    v_exp_f32 v37, v37
    s_add_u32 s51, s51, 1
    s_cmp_lt_u32 s51, 8
    s_cbranch_scc1 L_k_c_loop
    v_lshlrev_b32 v3, 4, v1
    s_mul_i32 s47, s44, 0x60000
    v_add_u32 v3, s47, v3
    s_lshl_b32 s48, s81, 12
    v_accvgpr_read_b32 v8, a0
    v_accvgpr_read_b32 v10, a4
    v_accvgpr_read_b32 v12, a8
    v_rcp_f32 v8, v8
    v_rcp_f32 v10, v10
    v_rcp_f32 v12, v12
    v_mov_b32 v9, v8
    v_mov_b32 v11, v10
    v_mov_b32 v13, v12
    v_pk_mul_f32 v[72:73], v[72:73], v[8:9]
    v_pk_mul_f32 v[74:75], v[74:75], v[8:9]
    v_pk_mul_f32 v[76:77], v[76:77], v[8:9]
    v_pk_mul_f32 v[78:79], v[78:79], v[8:9]
    v_cvt_pk_bf16_f32 v168, v72, v73
    v_cvt_pk_bf16_f32 v169, v74, v75
    v_cvt_pk_bf16_f32 v170, v76, v77
    v_cvt_pk_bf16_f32 v171, v78, v79
    buffer_store_dwordx4 v[168:171], v3, s[16:19], s48 offen offset:0 sc1
    v_pk_mul_f32 v[80:81], v[80:81], v[8:9]
    v_pk_mul_f32 v[82:83], v[82:83], v[8:9]
    v_pk_mul_f32 v[84:85], v[84:85], v[8:9]
    v_pk_mul_f32 v[86:87], v[86:87], v[8:9]
    v_cvt_pk_bf16_f32 v172, v80, v81
    v_cvt_pk_bf16_f32 v173, v82, v83
    v_cvt_pk_bf16_f32 v174, v84, v85
    v_cvt_pk_bf16_f32 v175, v86, v87
    buffer_store_dwordx4 v[172:175], v3, s[16:19], s48 offen offset:1024 sc1
    v_pk_mul_f32 v[88:89], v[88:89], v[8:9]
    v_pk_mul_f32 v[90:91], v[90:91], v[8:9]
    v_pk_mul_f32 v[92:93], v[92:93], v[8:9]
    v_pk_mul_f32 v[94:95], v[94:95], v[8:9]
    v_cvt_pk_bf16_f32 v176, v88, v89
    v_cvt_pk_bf16_f32 v177, v90, v91
    v_cvt_pk_bf16_f32 v178, v92, v93
    v_cvt_pk_bf16_f32 v179, v94, v95
    buffer_store_dwordx4 v[176:179], v3, s[16:19], s48 offen offset:2048 sc1
    v_pk_mul_f32 v[96:97], v[96:97], v[8:9]
    v_pk_mul_f32 v[98:99], v[98:99], v[8:9]
    v_pk_mul_f32 v[100:101], v[100:101], v[8:9]
    v_pk_mul_f32 v[102:103], v[102:103], v[8:9]
    v_cvt_pk_bf16_f32 v180, v96, v97
    v_cvt_pk_bf16_f32 v181, v98, v99
    v_cvt_pk_bf16_f32 v182, v100, v101
    v_cvt_pk_bf16_f32 v183, v102, v103
    buffer_store_dwordx4 v[180:183], v3, s[16:19], s48 offen offset:3072 sc1
    s_add_u32 s48, s48, 0x20000
    v_pk_mul_f32 v[104:105], v[104:105], v[10:11]
    v_pk_mul_f32 v[106:107], v[106:107], v[10:11]
    v_pk_mul_f32 v[108:109], v[108:109], v[10:11]
    v_pk_mul_f32 v[110:111], v[110:111], v[10:11]
    v_cvt_pk_bf16_f32 v184, v104, v105
    v_cvt_pk_bf16_f32 v185, v106, v107
    v_cvt_pk_bf16_f32 v186, v108, v109
    v_cvt_pk_bf16_f32 v187, v110, v111
    buffer_store_dwordx4 v[184:187], v3, s[16:19], s48 offen offset:0 sc1
    v_pk_mul_f32 v[112:113], v[112:113], v[10:11]
    v_pk_mul_f32 v[114:115], v[114:115], v[10:11]
    v_pk_mul_f32 v[116:117], v[116:117], v[10:11]
    v_pk_mul_f32 v[118:119], v[118:119], v[10:11]
    v_cvt_pk_bf16_f32 v188, v112, v113
    v_cvt_pk_bf16_f32 v189, v114, v115
    v_cvt_pk_bf16_f32 v190, v116, v117
    v_cvt_pk_bf16_f32 v191, v118, v119
    buffer_store_dwordx4 v[188:191], v3, s[16:19], s48 offen offset:1024 sc1
    v_pk_mul_f32 v[120:121], v[120:121], v[10:11]
    v_pk_mul_f32 v[122:123], v[122:123], v[10:11]
    v_pk_mul_f32 v[124:125], v[124:125], v[10:11]
    v_pk_mul_f32 v[126:127], v[126:127], v[10:11]
    v_cvt_pk_bf16_f32 v192, v120, v121
    v_cvt_pk_bf16_f32 v193, v122, v123
    v_cvt_pk_bf16_f32 v194, v124, v125
    v_cvt_pk_bf16_f32 v195, v126, v127
    buffer_store_dwordx4 v[192:195], v3, s[16:19], s48 offen offset:2048 sc1
    v_pk_mul_f32 v[128:129], v[128:129], v[10:11]
    v_pk_mul_f32 v[130:131], v[130:131], v[10:11]
    v_pk_mul_f32 v[132:133], v[132:133], v[10:11]
    v_pk_mul_f32 v[134:135], v[134:135], v[10:11]
    v_cvt_pk_bf16_f32 v196, v128, v129
    v_cvt_pk_bf16_f32 v197, v130, v131
    v_cvt_pk_bf16_f32 v198, v132, v133
    v_cvt_pk_bf16_f32 v199, v134, v135
    buffer_store_dwordx4 v[196:199], v3, s[16:19], s48 offen offset:3072 sc1
    s_add_u32 s48, s48, 0x20000
    v_pk_mul_f32 v[136:137], v[136:137], v[12:13]
    v_pk_mul_f32 v[138:139], v[138:139], v[12:13]
    v_pk_mul_f32 v[140:141], v[140:141], v[12:13]
    v_pk_mul_f32 v[142:143], v[142:143], v[12:13]
    v_cvt_pk_bf16_f32 v200, v136, v137
    v_cvt_pk_bf16_f32 v201, v138, v139
    v_cvt_pk_bf16_f32 v202, v140, v141
    v_cvt_pk_bf16_f32 v203, v142, v143
    buffer_store_dwordx4 v[200:203], v3, s[16:19], s48 offen offset:0 sc1
    v_pk_mul_f32 v[144:145], v[144:145], v[12:13]
    v_pk_mul_f32 v[146:147], v[146:147], v[12:13]
    v_pk_mul_f32 v[148:149], v[148:149], v[12:13]
    v_pk_mul_f32 v[150:151], v[150:151], v[12:13]
    v_cvt_pk_bf16_f32 v204, v144, v145
    v_cvt_pk_bf16_f32 v205, v146, v147
    v_cvt_pk_bf16_f32 v206, v148, v149
    v_cvt_pk_bf16_f32 v207, v150, v151
    buffer_store_dwordx4 v[204:207], v3, s[16:19], s48 offen offset:1024 sc1
    v_pk_mul_f32 v[152:153], v[152:153], v[12:13]
    v_pk_mul_f32 v[154:155], v[154:155], v[12:13]
    v_pk_mul_f32 v[156:157], v[156:157], v[12:13]
    v_pk_mul_f32 v[158:159], v[158:159], v[12:13]
    v_cvt_pk_bf16_f32 v208, v152, v153
    v_cvt_pk_bf16_f32 v209, v154, v155
    v_cvt_pk_bf16_f32 v210, v156, v157
    v_cvt_pk_bf16_f32 v211, v158, v159
    buffer_store_dwordx4 v[208:211], v3, s[16:19], s48 offen offset:2048 sc1
    v_pk_mul_f32 v[160:161], v[160:161], v[12:13]
    v_pk_mul_f32 v[162:163], v[162:163], v[12:13]
    v_pk_mul_f32 v[164:165], v[164:165], v[12:13]
    v_pk_mul_f32 v[166:167], v[166:167], v[12:13]
    v_cvt_pk_bf16_f32 v212, v160, v161
    v_cvt_pk_bf16_f32 v213, v162, v163
    v_cvt_pk_bf16_f32 v214, v164, v165
    v_cvt_pk_bf16_f32 v215, v166, v167
    buffer_store_dwordx4 v[212:215], v3, s[16:19], s48 offen offset:3072 sc1
    s_add_u32 s48, s48, 0x20000
    v_and_b32 v5, 3, v1
    v_lshlrev_b32 v5, 3, v5
    v_bfe_u32 v6, v1, 3, 2
    v_mul_u32_u24 v6, 0x420, v6
    v_add_u32 v5, v5, v6
    v_bfe_u32 v6, v1, 2, 1
    v_lshl_add_u32 v5, v6, 7, v5
    v_bfe_u32 v6, v1, 5, 1
    v_lshl_add_u32 v2, v6, 8, v5
    v_add_u32 v4, 0xf000, v2
    v_add_u32 v7, 0x1e000, v2
L_k_poll_wo0:
    ds_read_b32 v70, v0 offset:80
    s_waitcnt lgkmcnt(0)
    v_cmp_gt_u32 vcc, 1, v70
    s_cbranch_vccz L_k_pok_wo0
    s_sub_u32 s80, s80, 1
    s_cbranch_scc0 L_k_poll_wo0
    s_endpgm
L_k_pok_wo0:
    ds_read_b64_tr_b16 a[0:1], v4 offset:56832
    ds_read_b64_tr_b16 a[2:3], v4 offset:57344
    ds_read_b64_tr_b16 a[4:5], v4 offset:56864
    ds_read_b64_tr_b16 a[6:7], v4 offset:57376
    ds_read_b64_tr_b16 a[8:9], v4 offset:56896
    ds_read_b64_tr_b16 a[10:11], v4 offset:57408
    ds_read_b64_tr_b16 a[12:13], v4 offset:56928
    ds_read_b64_tr_b16 a[14:15], v4 offset:57440
    s_waitcnt lgkmcnt(6)
    v_mfma_f32_16x16x32_bf16 v[20:23], a[0:3], v[168:171], 0
    ds_read_b64_tr_b16 a[16:17], v4 offset:61056
    v_mfma_f32_16x16x32_bf16 v[36:39], a[0:3], v[184:187], 0
    ds_read_b64_tr_b16 a[18:19], v4 offset:61568
    v_mfma_f32_16x16x32_bf16 v[52:55], a[0:3], v[200:203], 0
    s_waitcnt lgkmcnt(6)
    v_mfma_f32_16x16x32_bf16 v[24:27], a[4:7], v[168:171], 0
    ds_read_b64_tr_b16 a[20:21], v4 offset:61088
    v_mfma_f32_16x16x32_bf16 v[40:43], a[4:7], v[184:187], 0
    ds_read_b64_tr_b16 a[22:23], v4 offset:61600
    v_mfma_f32_16x16x32_bf16 v[56:59], a[4:7], v[200:203], 0
    s_waitcnt lgkmcnt(6)
    v_mfma_f32_16x16x32_bf16 v[28:31], a[8:11], v[168:171], 0
    ds_read_b64_tr_b16 a[24:25], v4 offset:61120
    v_mfma_f32_16x16x32_bf16 v[44:47], a[8:11], v[184:187], 0
    ds_read_b64_tr_b16 a[26:27], v4 offset:61632
    v_mfma_f32_16x16x32_bf16 v[60:63], a[8:11], v[200:203], 0
    s_waitcnt lgkmcnt(6)
    v_mfma_f32_16x16x32_bf16 v[32:35], a[12:15], v[168:171], 0
    ds_read_b64_tr_b16 a[28:29], v4 offset:61152
    v_mfma_f32_16x16x32_bf16 v[48:51], a[12:15], v[184:187], 0
    ds_read_b64_tr_b16 a[30:31], v4 offset:61664
    v_mfma_f32_16x16x32_bf16 v[64:67], a[12:15], v[200:203], 0
    s_waitcnt lgkmcnt(6)
    v_mfma_f32_16x16x32_bf16 v[20:23], a[16:19], v[172:175], v[20:23]
    ds_read_b64_tr_b16 a[0:1], v7 offset:3840
    v_mfma_f32_16x16x32_bf16 v[36:39], a[16:19], v[188:191], v[36:39]
    ds_read_b64_tr_b16 a[2:3], v7 offset:4352
    v_mfma_f32_16x16x32_bf16 v[52:55], a[16:19], v[204:207], v[52:55]
    s_waitcnt lgkmcnt(6)
    v_mfma_f32_16x16x32_bf16 v[24:27], a[20:23], v[172:175], v[24:27]
    ds_read_b64_tr_b16 a[4:5], v7 offset:3872
    v_mfma_f32_16x16x32_bf16 v[40:43], a[20:23], v[188:191], v[40:43]
    ds_read_b64_tr_b16 a[6:7], v7 offset:4384
    v_mfma_f32_16x16x32_bf16 v[56:59], a[20:23], v[204:207], v[56:59]
    s_waitcnt lgkmcnt(6)
    v_mfma_f32_16x16x32_bf16 v[28:31], a[24:27], v[172:175], v[28:31]
    ds_read_b64_tr_b16 a[8:9], v7 offset:3904
    v_mfma_f32_16x16x32_bf16 v[44:47], a[24:27], v[188:191], v[44:47]
    ds_read_b64_tr_b16 a[10:11], v7 offset:4416
    v_mfma_f32_16x16x32_bf16 v[60:63], a[24:27], v[204:207], v[60:63]
    s_waitcnt lgkmcnt(6)
    v_mfma_f32_16x16x32_bf16 v[32:35], a[28:31], v[172:175], v[32:35]
    ds_read_b64_tr_b16 a[12:13], v7 offset:3936
    v_mfma_f32_16x16x32_bf16 v[48:51], a[28:31], v[188:191], v[48:51]
    ds_read_b64_tr_b16 a[14:15], v7 offset:4448
    v_mfma_f32_16x16x32_bf16 v[64:67], a[28:31], v[204:207], v[64:67]
    s_waitcnt lgkmcnt(6)
    v_mfma_f32_16x16x32_bf16 v[20:23], a[0:3], v[176:179], v[20:23]
    ds_read_b64_tr_b16 a[16:17], v7 offset:8064
    v_mfma_f32_16x16x32_bf16 v[36:39], a[0:3], v[192:195], v[36:39]
    ds_read_b64_tr_b16 a[18:19], v7 offset:8576
    v_mfma_f32_16x16x32_bf16 v[52:55], a[0:3], v[208:211], v[52:55]
    s_waitcnt lgkmcnt(6)
    v_mfma_f32_16x16x32_bf16 v[24:27], a[4:7], v[176:179], v[24:27]
    ds_read_b64_tr_b16 a[20:21], v7 offset:8096
    v_mfma_f32_16x16x32_bf16 v[40:43], a[4:7], v[192:195], v[40:43]
    ds_read_b64_tr_b16 a[22:23], v7 offset:8608
    v_mfma_f32_16x16x32_bf16 v[56:59], a[4:7], v[208:211], v[56:59]
    s_waitcnt lgkmcnt(6)
    v_mfma_f32_16x16x32_bf16 v[28:31], a[8:11], v[176:179], v[28:31]
    ds_read_b64_tr_b16 a[24:25], v7 offset:8128
    v_mfma_f32_16x16x32_bf16 v[44:47], a[8:11], v[192:195], v[44:47]
    ds_read_b64_tr_b16 a[26:27], v7 offset:8640
    v_mfma_f32_16x16x32_bf16 v[60:63], a[8:11], v[208:211], v[60:63]
    s_waitcnt lgkmcnt(6)
    v_mfma_f32_16x16x32_bf16 v[32:35], a[12:15], v[176:179], v[32:35]
    ds_read_b64_tr_b16 a[28:29], v7 offset:8160
    v_mfma_f32_16x16x32_bf16 v[48:51], a[12:15], v[192:195], v[48:51]
    ds_read_b64_tr_b16 a[30:31], v7 offset:8672
    v_mfma_f32_16x16x32_bf16 v[64:67], a[12:15], v[208:211], v[64:67]
    s_waitcnt lgkmcnt(6)
    v_mfma_f32_16x16x32_bf16 v[20:23], a[16:19], v[180:183], v[20:23]
    v_mfma_f32_16x16x32_bf16 v[36:39], a[16:19], v[196:199], v[36:39]
    v_mfma_f32_16x16x32_bf16 v[52:55], a[16:19], v[212:215], v[52:55]
    s_waitcnt lgkmcnt(4)
    v_mfma_f32_16x16x32_bf16 v[24:27], a[20:23], v[180:183], v[24:27]
    v_mfma_f32_16x16x32_bf16 v[40:43], a[20:23], v[196:199], v[40:43]
    v_mfma_f32_16x16x32_bf16 v[56:59], a[20:23], v[212:215], v[56:59]
    s_waitcnt lgkmcnt(2)
    v_mfma_f32_16x16x32_bf16 v[28:31], a[24:27], v[180:183], v[28:31]
    v_mfma_f32_16x16x32_bf16 v[44:47], a[24:27], v[196:199], v[44:47]
    v_mfma_f32_16x16x32_bf16 v[60:63], a[24:27], v[212:215], v[60:63]
    s_waitcnt lgkmcnt(0)
    v_mfma_f32_16x16x32_bf16 v[32:35], a[28:31], v[180:183], v[32:35]
    v_mfma_f32_16x16x32_bf16 v[48:51], a[28:31], v[196:199], v[48:51]
    v_mfma_f32_16x16x32_bf16 v[64:67], a[28:31], v[212:215], v[64:67]
    s_lshl_b32 s47, s81, 2
    s_add_u32 s49, s47, s83
    ds_read_b32 v70, v0 offset:112
    s_waitcnt lgkmcnt(0)
    v_cmp_gt_u32 vcc, 2, v70
    s_cbranch_vccnz L_k_c_late
    s_add_u32 s48, s81, 1
    s_and_b32 s48, s48, 7
    s_lshl_b32 s48, s48, 12
    s_add_u32 s62, s48, 0x20000
    s_add_u32 s50, s48, 0x40000
    buffer_load_dwordx4 v[72:75], v3, s[16:19], s48 offen offset:0
    buffer_load_dwordx4 v[88:91], v3, s[16:19], s62 offen offset:0
    buffer_load_dwordx4 v[104:107], v3, s[16:19], s50 offen offset:0
    buffer_load_dwordx4 v[76:79], v3, s[16:19], s48 offen offset:1024
    buffer_load_dwordx4 v[92:95], v3, s[16:19], s62 offen offset:1024
    buffer_load_dwordx4 v[108:111], v3, s[16:19], s50 offen offset:1024
    buffer_load_dwordx4 v[80:83], v3, s[16:19], s48 offen offset:2048
    buffer_load_dwordx4 v[96:99], v3, s[16:19], s62 offen offset:2048
    buffer_load_dwordx4 v[112:115], v3, s[16:19], s50 offen offset:2048
    buffer_load_dwordx4 v[84:87], v3, s[16:19], s48 offen offset:3072
    buffer_load_dwordx4 v[100:103], v3, s[16:19], s62 offen offset:3072
    buffer_load_dwordx4 v[116:119], v3, s[16:19], s50 offen offset:3072
    s_add_u32 s48, s81, 2
    s_and_b32 s48, s48, 7
    s_lshl_b32 s48, s48, 12
    s_add_u32 s62, s48, 0x20000
    s_add_u32 s50, s48, 0x40000
    buffer_load_dwordx4 v[120:123], v3, s[16:19], s48 offen offset:0
    buffer_load_dwordx4 v[136:139], v3, s[16:19], s62 offen offset:0
    buffer_load_dwordx4 v[152:155], v3, s[16:19], s50 offen offset:0
    buffer_load_dwordx4 v[124:127], v3, s[16:19], s48 offen offset:1024
    buffer_load_dwordx4 v[140:143], v3, s[16:19], s62 offen offset:1024
    buffer_load_dwordx4 v[156:159], v3, s[16:19], s50 offen offset:1024
    buffer_load_dwordx4 v[128:131], v3, s[16:19], s48 offen offset:2048
    buffer_load_dwordx4 v[144:147], v3, s[16:19], s62 offen offset:2048
    buffer_load_dwordx4 v[160:163], v3, s[16:19], s50 offen offset:2048
    buffer_load_dwordx4 v[132:135], v3, s[16:19], s48 offen offset:3072
    buffer_load_dwordx4 v[148:151], v3, s[16:19], s62 offen offset:3072
    buffer_load_dwordx4 v[164:167], v3, s[16:19], s50 offen offset:3072
    s_waitcnt vmcnt(24)
    v_mov_b32 v5, 1
    s_mov_b64 exec, 1
    ds_add_rtn_u32 v6, v0, v5 offset:96
    s_waitcnt lgkmcnt(0)
    v_cmp_eq_u32 vcc, 5, v6
    s_cbranch_vccz L_k_arr_c1a
L_k_poll_noncec1a:
    ds_read_b32 v5, v0 offset:116
    s_waitcnt lgkmcnt(0)
    v_cmp_gt_u32 vcc, 1, v5
    s_cbranch_vccz L_k_pok_noncec1a
    s_sleep 1
    s_sub_u32 s80, s80, 1
    s_cbranch_scc0 L_k_poll_noncec1a
    s_endpgm
L_k_pok_noncec1a:
    v_mov_b32 v6, s49
    buffer_store_dword v5, v6, s[72:75], 0 offen sc1
L_k_arr_c1a:
    s_mov_b64 exec, -1
    s_branch L_k_c_go
L_k_c_late:
    s_waitcnt vmcnt(0)
    v_mov_b32 v5, 1
    s_mov_b64 exec, 1
    ds_add_rtn_u32 v6, v0, v5 offset:96
    s_waitcnt lgkmcnt(0)
    v_cmp_eq_u32 vcc, 5, v6
    s_cbranch_vccz L_k_arr_c1b
L_k_poll_noncec1b:
    ds_read_b32 v5, v0 offset:116
    s_waitcnt lgkmcnt(0)
    v_cmp_gt_u32 vcc, 1, v5
    s_cbranch_vccz L_k_pok_noncec1b
    s_sleep 1
    s_sub_u32 s80, s80, 1
    s_cbranch_scc0 L_k_poll_noncec1b
    s_endpgm
L_k_pok_noncec1b:
    v_mov_b32 v6, s49
    buffer_store_dword v5, v6, s[72:75], 0 offen sc1
L_k_arr_c1b:
    s_mov_b64 exec, -1
L_k_poll_o1:
    ds_read_b32 v70, v0 offset:112
    s_waitcnt lgkmcnt(0)
    v_cmp_gt_u32 vcc, 1, v70
    s_cbranch_vccz L_k_pok_o1
    s_sub_u32 s80, s80, 1
    s_cbranch_scc0 L_k_poll_o1
    s_endpgm
L_k_pok_o1:
    s_add_u32 s48, s81, 1
    s_and_b32 s48, s48, 7
    s_lshl_b32 s48, s48, 12
    s_add_u32 s62, s48, 0x20000
    s_add_u32 s50, s48, 0x40000
    buffer_load_dwordx4 v[72:75], v3, s[16:19], s48 offen offset:0
    buffer_load_dwordx4 v[88:91], v3, s[16:19], s62 offen offset:0
    buffer_load_dwordx4 v[104:107], v3, s[16:19], s50 offen offset:0
    buffer_load_dwordx4 v[76:79], v3, s[16:19], s48 offen offset:1024
    buffer_load_dwordx4 v[92:95], v3, s[16:19], s62 offen offset:1024
    buffer_load_dwordx4 v[108:111], v3, s[16:19], s50 offen offset:1024
    buffer_load_dwordx4 v[80:83], v3, s[16:19], s48 offen offset:2048
    buffer_load_dwordx4 v[96:99], v3, s[16:19], s62 offen offset:2048
    buffer_load_dwordx4 v[112:115], v3, s[16:19], s50 offen offset:2048
    buffer_load_dwordx4 v[84:87], v3, s[16:19], s48 offen offset:3072
    buffer_load_dwordx4 v[100:103], v3, s[16:19], s62 offen offset:3072
    buffer_load_dwordx4 v[116:119], v3, s[16:19], s50 offen offset:3072
L_k_poll_o2:
    ds_read_b32 v70, v0 offset:112
    s_waitcnt lgkmcnt(0)
    v_cmp_gt_u32 vcc, 2, v70
    s_cbranch_vccz L_k_pok_o2
    s_sub_u32 s80, s80, 1
    s_cbranch_scc0 L_k_poll_o2
    s_endpgm
L_k_pok_o2:
    s_add_u32 s48, s81, 2
    s_and_b32 s48, s48, 7
    s_lshl_b32 s48, s48, 12
    s_add_u32 s62, s48, 0x20000
    s_add_u32 s50, s48, 0x40000
    buffer_load_dwordx4 v[120:123], v3, s[16:19], s48 offen offset:0
    buffer_load_dwordx4 v[136:139], v3, s[16:19], s62 offen offset:0
    buffer_load_dwordx4 v[152:155], v3, s[16:19], s50 offen offset:0
    buffer_load_dwordx4 v[124:127], v3, s[16:19], s48 offen offset:1024
    buffer_load_dwordx4 v[140:143], v3, s[16:19], s62 offen offset:1024
    buffer_load_dwordx4 v[156:159], v3, s[16:19], s50 offen offset:1024
    buffer_load_dwordx4 v[128:131], v3, s[16:19], s48 offen offset:2048
    buffer_load_dwordx4 v[144:147], v3, s[16:19], s62 offen offset:2048
    buffer_load_dwordx4 v[160:163], v3, s[16:19], s50 offen offset:2048
    buffer_load_dwordx4 v[132:135], v3, s[16:19], s48 offen offset:3072
    buffer_load_dwordx4 v[148:151], v3, s[16:19], s62 offen offset:3072
    buffer_load_dwordx4 v[164:167], v3, s[16:19], s50 offen offset:3072
L_k_c_go:
L_k_poll_wo1:
    ds_read_b32 v70, v0 offset:84
    s_waitcnt lgkmcnt(0)
    v_cmp_gt_u32 vcc, 1, v70
    s_cbranch_vccz L_k_pok_wo1
    s_sub_u32 s80, s80, 1
    s_cbranch_scc0 L_k_poll_wo1
    s_endpgm
L_k_pok_wo1:
    ds_read_b64_tr_b16 a[0:1], v7 offset:12288
    ds_read_b64_tr_b16 a[2:3], v7 offset:12800
    ds_read_b64_tr_b16 a[4:5], v7 offset:12320
    ds_read_b64_tr_b16 a[6:7], v7 offset:12832
    ds_read_b64_tr_b16 a[8:9], v7 offset:12352
    ds_read_b64_tr_b16 a[10:11], v7 offset:12864
    ds_read_b64_tr_b16 a[12:13], v7 offset:12384
    ds_read_b64_tr_b16 a[14:15], v7 offset:12896
    s_waitcnt vmcnt(23) lgkmcnt(4)
    v_mfma_f32_16x16x32_bf16 v[20:23], a[0:3], v[72:75], v[20:23]
    ds_read_b64_tr_b16 a[16:17], v7 offset:16512
    s_waitcnt vmcnt(22)
    v_mfma_f32_16x16x32_bf16 v[36:39], a[0:3], v[88:91], v[36:39]
    ds_read_b64_tr_b16 a[18:19], v7 offset:17024
    s_waitcnt vmcnt(21)
    v_mfma_f32_16x16x32_bf16 v[52:55], a[0:3], v[104:107], v[52:55]
    ds_read_b32 v70, v0 offset:112
    v_mfma_f32_16x16x32_bf16 v[24:27], a[4:7], v[72:75], v[24:27]
    ds_read_b64_tr_b16 a[20:21], v7 offset:16544
    v_mfma_f32_16x16x32_bf16 v[40:43], a[4:7], v[88:91], v[40:43]
    ds_read_b64_tr_b16 a[22:23], v7 offset:17056
    v_mfma_f32_16x16x32_bf16 v[56:59], a[4:7], v[104:107], v[56:59]
    s_waitcnt lgkmcnt(5)
    v_mfma_f32_16x16x32_bf16 v[28:31], a[8:11], v[72:75], v[28:31]
    ds_read_b64_tr_b16 a[24:25], v7 offset:16576
    v_mfma_f32_16x16x32_bf16 v[44:47], a[8:11], v[88:91], v[44:47]
    ds_read_b64_tr_b16 a[26:27], v7 offset:17088
    v_mfma_f32_16x16x32_bf16 v[60:63], a[8:11], v[104:107], v[60:63]
    v_mfma_f32_16x16x32_bf16 v[32:35], a[12:15], v[72:75], v[32:35]
    ds_read_b64_tr_b16 a[28:29], v7 offset:16608
    v_mfma_f32_16x16x32_bf16 v[48:51], a[12:15], v[88:91], v[48:51]
    ds_read_b64_tr_b16 a[30:31], v7 offset:17120
    v_mfma_f32_16x16x32_bf16 v[64:67], a[12:15], v[104:107], v[64:67]
    s_waitcnt lgkmcnt(6)
    v_cmp_gt_u32 vcc, 3, v70
    s_cbranch_vccnz L_k_spin_po1
L_k_ret_po1:
    s_waitcnt vmcnt(20)
    v_mfma_f32_16x16x32_bf16 v[20:23], a[16:19], v[76:79], v[20:23]
    ds_read_b64_tr_b16 a[0:1], v7 offset:20736
    s_add_u32 s48, s81, 3
    s_and_b32 s48, s48, 7
    s_waitcnt vmcnt(19)
    v_mfma_f32_16x16x32_bf16 v[36:39], a[16:19], v[92:95], v[36:39]
    ds_read_b64_tr_b16 a[2:3], v7 offset:21248
    s_lshl_b32 s48, s48, 12
    s_add_u32 s62, s48, 0x20000
    s_waitcnt vmcnt(18)
    v_mfma_f32_16x16x32_bf16 v[52:55], a[16:19], v[108:111], v[52:55]
    s_add_u32 s50, s48, 0x40000
    buffer_load_dwordx4 v[168:171], v3, s[16:19], s48 offen offset:0
    s_waitcnt lgkmcnt(4)
    v_mfma_f32_16x16x32_bf16 v[24:27], a[20:23], v[76:79], v[24:27]
    ds_read_b64_tr_b16 a[4:5], v7 offset:20768
    buffer_load_dwordx4 v[184:187], v3, s[16:19], s62 offen offset:0
    v_mfma_f32_16x16x32_bf16 v[40:43], a[20:23], v[92:95], v[40:43]
    ds_read_b64_tr_b16 a[6:7], v7 offset:21280
    buffer_load_dwordx4 v[200:203], v3, s[16:19], s50 offen offset:0
    v_mfma_f32_16x16x32_bf16 v[56:59], a[20:23], v[108:111], v[56:59]
    buffer_load_dwordx4 v[172:175], v3, s[16:19], s48 offen offset:1024
    buffer_load_dwordx4 v[188:191], v3, s[16:19], s62 offen offset:1024
    v_mfma_f32_16x16x32_bf16 v[28:31], a[24:27], v[76:79], v[28:31]
    ds_read_b64_tr_b16 a[8:9], v7 offset:20800
    buffer_load_dwordx4 v[204:207], v3, s[16:19], s50 offen offset:1024
    v_mfma_f32_16x16x32_bf16 v[44:47], a[24:27], v[92:95], v[44:47]
    ds_read_b64_tr_b16 a[10:11], v7 offset:21312
    buffer_load_dwordx4 v[176:179], v3, s[16:19], s48 offen offset:2048
    v_mfma_f32_16x16x32_bf16 v[60:63], a[24:27], v[108:111], v[60:63]
    ds_read_b32 v71, v0 offset:80
    buffer_load_dwordx4 v[192:195], v3, s[16:19], s62 offen offset:2048
    s_waitcnt lgkmcnt(5)
    v_mfma_f32_16x16x32_bf16 v[32:35], a[28:31], v[76:79], v[32:35]
    ds_read_b64_tr_b16 a[12:13], v7 offset:20832
    buffer_load_dwordx4 v[208:211], v3, s[16:19], s50 offen offset:2048
    v_mfma_f32_16x16x32_bf16 v[48:51], a[28:31], v[92:95], v[48:51]
    ds_read_b64_tr_b16 a[14:15], v7 offset:21344
    buffer_load_dwordx4 v[180:183], v3, s[16:19], s48 offen offset:3072
    v_mfma_f32_16x16x32_bf16 v[64:67], a[28:31], v[108:111], v[64:67]
    buffer_load_dwordx4 v[196:199], v3, s[16:19], s62 offen offset:3072
    buffer_load_dwordx4 v[212:215], v3, s[16:19], s50 offen offset:3072
    s_waitcnt vmcnt(29)
    v_mfma_f32_16x16x32_bf16 v[20:23], a[0:3], v[80:83], v[20:23]
    ds_read_b64_tr_b16 a[16:17], v7 offset:24960
    s_waitcnt vmcnt(28)
    v_mfma_f32_16x16x32_bf16 v[36:39], a[0:3], v[96:99], v[36:39]
    ds_read_b64_tr_b16 a[18:19], v7 offset:25472
    s_waitcnt vmcnt(27)
    v_mfma_f32_16x16x32_bf16 v[52:55], a[0:3], v[112:115], v[52:55]
    s_waitcnt lgkmcnt(5)
    v_mfma_f32_16x16x32_bf16 v[24:27], a[4:7], v[80:83], v[24:27]
    ds_read_b64_tr_b16 a[20:21], v7 offset:24992
    v_mfma_f32_16x16x32_bf16 v[40:43], a[4:7], v[96:99], v[40:43]
    ds_read_b64_tr_b16 a[22:23], v7 offset:25504
    v_mfma_f32_16x16x32_bf16 v[56:59], a[4:7], v[112:115], v[56:59]
    v_mfma_f32_16x16x32_bf16 v[28:31], a[8:11], v[80:83], v[28:31]
    ds_read_b64_tr_b16 a[24:25], v7 offset:25024
    v_mfma_f32_16x16x32_bf16 v[44:47], a[8:11], v[96:99], v[44:47]
    ds_read_b64_tr_b16 a[26:27], v7 offset:25536
    v_mfma_f32_16x16x32_bf16 v[60:63], a[8:11], v[112:115], v[60:63]
    s_waitcnt lgkmcnt(6)
    v_mfma_f32_16x16x32_bf16 v[32:35], a[12:15], v[80:83], v[32:35]
    ds_read_b64_tr_b16 a[28:29], v7 offset:25056
    v_mfma_f32_16x16x32_bf16 v[48:51], a[12:15], v[96:99], v[48:51]
    ds_read_b64_tr_b16 a[30:31], v7 offset:25568
    v_mfma_f32_16x16x32_bf16 v[64:67], a[12:15], v[112:115], v[64:67]
    v_cmp_gt_u32 vcc, 2, v71
    s_cbranch_vccnz L_k_spin_pw1
L_k_ret_pw1:
    s_waitcnt vmcnt(26) lgkmcnt(4)
    v_mfma_f32_16x16x32_bf16 v[20:23], a[16:19], v[84:87], v[20:23]
    ds_read_b64_tr_b16 a[0:1], v2 offset:0
    s_waitcnt vmcnt(25)
    v_mfma_f32_16x16x32_bf16 v[36:39], a[16:19], v[100:103], v[36:39]
    ds_read_b64_tr_b16 a[2:3], v2 offset:512
    s_waitcnt vmcnt(24)
    v_mfma_f32_16x16x32_bf16 v[52:55], a[16:19], v[116:119], v[52:55]
    v_mfma_f32_16x16x32_bf16 v[24:27], a[20:23], v[84:87], v[24:27]
    ds_read_b64_tr_b16 a[4:5], v2 offset:32
    v_mfma_f32_16x16x32_bf16 v[40:43], a[20:23], v[100:103], v[40:43]
    ds_read_b64_tr_b16 a[6:7], v2 offset:544
    v_mfma_f32_16x16x32_bf16 v[56:59], a[20:23], v[116:119], v[56:59]
    s_waitcnt lgkmcnt(4)
    v_mfma_f32_16x16x32_bf16 v[28:31], a[24:27], v[84:87], v[28:31]
    ds_read_b64_tr_b16 a[8:9], v2 offset:64
    v_mfma_f32_16x16x32_bf16 v[44:47], a[24:27], v[100:103], v[44:47]
    ds_read_b64_tr_b16 a[10:11], v2 offset:576
    v_mfma_f32_16x16x32_bf16 v[60:63], a[24:27], v[116:119], v[60:63]
    v_mfma_f32_16x16x32_bf16 v[32:35], a[28:31], v[84:87], v[32:35]
    ds_read_b64_tr_b16 a[12:13], v2 offset:96
    v_mfma_f32_16x16x32_bf16 v[48:51], a[28:31], v[100:103], v[48:51]
    ds_read_b64_tr_b16 a[14:15], v2 offset:608
    v_mfma_f32_16x16x32_bf16 v[64:67], a[28:31], v[116:119], v[64:67]
    s_waitcnt vmcnt(23) lgkmcnt(4)
    v_mfma_f32_16x16x32_bf16 v[20:23], a[0:3], v[120:123], v[20:23]
    ds_read_b64_tr_b16 a[16:17], v2 offset:4224
    s_waitcnt vmcnt(22)
    v_mfma_f32_16x16x32_bf16 v[36:39], a[0:3], v[136:139], v[36:39]
    ds_read_b64_tr_b16 a[18:19], v2 offset:4736
    s_waitcnt vmcnt(21)
    v_mfma_f32_16x16x32_bf16 v[52:55], a[0:3], v[152:155], v[52:55]
    ds_read_b32 v70, v0 offset:112
    v_mfma_f32_16x16x32_bf16 v[24:27], a[4:7], v[120:123], v[24:27]
    ds_read_b64_tr_b16 a[20:21], v2 offset:4256
    v_mfma_f32_16x16x32_bf16 v[40:43], a[4:7], v[136:139], v[40:43]
    ds_read_b64_tr_b16 a[22:23], v2 offset:4768
    v_mfma_f32_16x16x32_bf16 v[56:59], a[4:7], v[152:155], v[56:59]
    s_waitcnt lgkmcnt(5)
    v_mfma_f32_16x16x32_bf16 v[28:31], a[8:11], v[120:123], v[28:31]
    ds_read_b64_tr_b16 a[24:25], v2 offset:4288
    v_mfma_f32_16x16x32_bf16 v[44:47], a[8:11], v[136:139], v[44:47]
    ds_read_b64_tr_b16 a[26:27], v2 offset:4800
    v_mfma_f32_16x16x32_bf16 v[60:63], a[8:11], v[152:155], v[60:63]
    v_mfma_f32_16x16x32_bf16 v[32:35], a[12:15], v[120:123], v[32:35]
    ds_read_b64_tr_b16 a[28:29], v2 offset:4320
    v_mfma_f32_16x16x32_bf16 v[48:51], a[12:15], v[136:139], v[48:51]
    ds_read_b64_tr_b16 a[30:31], v2 offset:4832
    v_mfma_f32_16x16x32_bf16 v[64:67], a[12:15], v[152:155], v[64:67]
    s_waitcnt lgkmcnt(6)
    v_cmp_gt_u32 vcc, 4, v70
    s_cbranch_vccnz L_k_spin_po2
L_k_ret_po2:
    s_waitcnt vmcnt(20)
    v_mfma_f32_16x16x32_bf16 v[20:23], a[16:19], v[124:127], v[20:23]
    ds_read_b64_tr_b16 a[0:1], v2 offset:8448
    s_add_u32 s48, s81, 4
    s_and_b32 s48, s48, 7
    s_waitcnt vmcnt(19)
    v_mfma_f32_16x16x32_bf16 v[36:39], a[16:19], v[140:143], v[36:39]
    ds_read_b64_tr_b16 a[2:3], v2 offset:8960
    s_lshl_b32 s48, s48, 12
    s_add_u32 s62, s48, 0x20000
    s_waitcnt vmcnt(18)
    v_mfma_f32_16x16x32_bf16 v[52:55], a[16:19], v[156:159], v[52:55]
    s_add_u32 s50, s48, 0x40000
    buffer_load_dwordx4 v[72:75], v3, s[16:19], s48 offen offset:0
    s_waitcnt lgkmcnt(4)
    v_mfma_f32_16x16x32_bf16 v[24:27], a[20:23], v[124:127], v[24:27]
    ds_read_b64_tr_b16 a[4:5], v2 offset:8480
    buffer_load_dwordx4 v[88:91], v3, s[16:19], s62 offen offset:0
    v_mfma_f32_16x16x32_bf16 v[40:43], a[20:23], v[140:143], v[40:43]
    ds_read_b64_tr_b16 a[6:7], v2 offset:8992
    buffer_load_dwordx4 v[104:107], v3, s[16:19], s50 offen offset:0
    v_mfma_f32_16x16x32_bf16 v[56:59], a[20:23], v[156:159], v[56:59]
    buffer_load_dwordx4 v[76:79], v3, s[16:19], s48 offen offset:1024
    buffer_load_dwordx4 v[92:95], v3, s[16:19], s62 offen offset:1024
    v_mfma_f32_16x16x32_bf16 v[28:31], a[24:27], v[124:127], v[28:31]
    ds_read_b64_tr_b16 a[8:9], v2 offset:8512
    buffer_load_dwordx4 v[108:111], v3, s[16:19], s50 offen offset:1024
    v_mfma_f32_16x16x32_bf16 v[44:47], a[24:27], v[140:143], v[44:47]
    ds_read_b64_tr_b16 a[10:11], v2 offset:9024
    buffer_load_dwordx4 v[80:83], v3, s[16:19], s48 offen offset:2048
    v_mfma_f32_16x16x32_bf16 v[60:63], a[24:27], v[156:159], v[60:63]
    ds_read_b32 v71, v0 offset:84
    buffer_load_dwordx4 v[96:99], v3, s[16:19], s62 offen offset:2048
    s_waitcnt lgkmcnt(5)
    v_mfma_f32_16x16x32_bf16 v[32:35], a[28:31], v[124:127], v[32:35]
    ds_read_b64_tr_b16 a[12:13], v2 offset:8544
    buffer_load_dwordx4 v[112:115], v3, s[16:19], s50 offen offset:2048
    v_mfma_f32_16x16x32_bf16 v[48:51], a[28:31], v[140:143], v[48:51]
    ds_read_b64_tr_b16 a[14:15], v2 offset:9056
    buffer_load_dwordx4 v[84:87], v3, s[16:19], s48 offen offset:3072
    v_mfma_f32_16x16x32_bf16 v[64:67], a[28:31], v[156:159], v[64:67]
    buffer_load_dwordx4 v[100:103], v3, s[16:19], s62 offen offset:3072
    buffer_load_dwordx4 v[116:119], v3, s[16:19], s50 offen offset:3072
    s_waitcnt vmcnt(29)
    v_mfma_f32_16x16x32_bf16 v[20:23], a[0:3], v[128:131], v[20:23]
    ds_read_b64_tr_b16 a[16:17], v2 offset:12672
    s_waitcnt vmcnt(28)
    v_mfma_f32_16x16x32_bf16 v[36:39], a[0:3], v[144:147], v[36:39]
    ds_read_b64_tr_b16 a[18:19], v2 offset:13184
    s_waitcnt vmcnt(27)
    v_mfma_f32_16x16x32_bf16 v[52:55], a[0:3], v[160:163], v[52:55]
    s_waitcnt lgkmcnt(5)
    v_mfma_f32_16x16x32_bf16 v[24:27], a[4:7], v[128:131], v[24:27]
    ds_read_b64_tr_b16 a[20:21], v2 offset:12704
    v_mfma_f32_16x16x32_bf16 v[40:43], a[4:7], v[144:147], v[40:43]
    ds_read_b64_tr_b16 a[22:23], v2 offset:13216
    v_mfma_f32_16x16x32_bf16 v[56:59], a[4:7], v[160:163], v[56:59]
    v_mfma_f32_16x16x32_bf16 v[28:31], a[8:11], v[128:131], v[28:31]
    ds_read_b64_tr_b16 a[24:25], v2 offset:12736
    v_mfma_f32_16x16x32_bf16 v[44:47], a[8:11], v[144:147], v[44:47]
    ds_read_b64_tr_b16 a[26:27], v2 offset:13248
    v_mfma_f32_16x16x32_bf16 v[60:63], a[8:11], v[160:163], v[60:63]
    s_waitcnt lgkmcnt(6)
    v_mfma_f32_16x16x32_bf16 v[32:35], a[12:15], v[128:131], v[32:35]
    ds_read_b64_tr_b16 a[28:29], v2 offset:12768
    v_mfma_f32_16x16x32_bf16 v[48:51], a[12:15], v[144:147], v[48:51]
    ds_read_b64_tr_b16 a[30:31], v2 offset:13280
    v_mfma_f32_16x16x32_bf16 v[64:67], a[12:15], v[160:163], v[64:67]
    v_cmp_gt_u32 vcc, 2, v71
    s_cbranch_vccnz L_k_spin_pw2
L_k_ret_pw2:
    s_waitcnt vmcnt(26) lgkmcnt(4)
    v_mfma_f32_16x16x32_bf16 v[20:23], a[16:19], v[132:135], v[20:23]
    ds_read_b64_tr_b16 a[0:1], v2 offset:16896
    s_waitcnt vmcnt(25)
    v_mfma_f32_16x16x32_bf16 v[36:39], a[16:19], v[148:151], v[36:39]
    ds_read_b64_tr_b16 a[2:3], v2 offset:17408
    s_waitcnt vmcnt(24)
    v_mfma_f32_16x16x32_bf16 v[52:55], a[16:19], v[164:167], v[52:55]
    v_mfma_f32_16x16x32_bf16 v[24:27], a[20:23], v[132:135], v[24:27]
    ds_read_b64_tr_b16 a[4:5], v2 offset:16928
    v_mfma_f32_16x16x32_bf16 v[40:43], a[20:23], v[148:151], v[40:43]
    ds_read_b64_tr_b16 a[6:7], v2 offset:17440
    v_mfma_f32_16x16x32_bf16 v[56:59], a[20:23], v[164:167], v[56:59]
    s_waitcnt lgkmcnt(4)
    v_mfma_f32_16x16x32_bf16 v[28:31], a[24:27], v[132:135], v[28:31]
    ds_read_b64_tr_b16 a[8:9], v2 offset:16960
    v_mfma_f32_16x16x32_bf16 v[44:47], a[24:27], v[148:151], v[44:47]
    ds_read_b64_tr_b16 a[10:11], v2 offset:17472
    v_mfma_f32_16x16x32_bf16 v[60:63], a[24:27], v[164:167], v[60:63]
    v_mfma_f32_16x16x32_bf16 v[32:35], a[28:31], v[132:135], v[32:35]
    ds_read_b64_tr_b16 a[12:13], v2 offset:16992
    v_mfma_f32_16x16x32_bf16 v[48:51], a[28:31], v[148:151], v[48:51]
    ds_read_b64_tr_b16 a[14:15], v2 offset:17504
    v_mfma_f32_16x16x32_bf16 v[64:67], a[28:31], v[164:167], v[64:67]
    s_waitcnt vmcnt(23) lgkmcnt(4)
    v_mfma_f32_16x16x32_bf16 v[20:23], a[0:3], v[168:171], v[20:23]
    ds_read_b64_tr_b16 a[16:17], v2 offset:21120
    s_waitcnt vmcnt(22)
    v_mfma_f32_16x16x32_bf16 v[36:39], a[0:3], v[184:187], v[36:39]
    ds_read_b64_tr_b16 a[18:19], v2 offset:21632
    s_waitcnt vmcnt(21)
    v_mfma_f32_16x16x32_bf16 v[52:55], a[0:3], v[200:203], v[52:55]
    ds_read_b32 v70, v0 offset:112
    v_mfma_f32_16x16x32_bf16 v[24:27], a[4:7], v[168:171], v[24:27]
    ds_read_b64_tr_b16 a[20:21], v2 offset:21152
    v_mfma_f32_16x16x32_bf16 v[40:43], a[4:7], v[184:187], v[40:43]
    ds_read_b64_tr_b16 a[22:23], v2 offset:21664
    v_mfma_f32_16x16x32_bf16 v[56:59], a[4:7], v[200:203], v[56:59]
    s_waitcnt lgkmcnt(5)
    v_mfma_f32_16x16x32_bf16 v[28:31], a[8:11], v[168:171], v[28:31]
    ds_read_b64_tr_b16 a[24:25], v2 offset:21184
    v_mfma_f32_16x16x32_bf16 v[44:47], a[8:11], v[184:187], v[44:47]
    ds_read_b64_tr_b16 a[26:27], v2 offset:21696
    v_mfma_f32_16x16x32_bf16 v[60:63], a[8:11], v[200:203], v[60:63]
    v_mfma_f32_16x16x32_bf16 v[32:35], a[12:15], v[168:171], v[32:35]
    ds_read_b64_tr_b16 a[28:29], v2 offset:21216
    v_mfma_f32_16x16x32_bf16 v[48:51], a[12:15], v[184:187], v[48:51]
    ds_read_b64_tr_b16 a[30:31], v2 offset:21728
    v_mfma_f32_16x16x32_bf16 v[64:67], a[12:15], v[200:203], v[64:67]
    s_waitcnt lgkmcnt(6)
    v_cmp_gt_u32 vcc, 5, v70
    s_cbranch_vccnz L_k_spin_po3
L_k_ret_po3:
    s_waitcnt vmcnt(20)
    v_mfma_f32_16x16x32_bf16 v[20:23], a[16:19], v[172:175], v[20:23]
    ds_read_b64_tr_b16 a[0:1], v2 offset:25344
    s_add_u32 s48, s81, 5
    s_and_b32 s48, s48, 7
    s_waitcnt vmcnt(19)
    v_mfma_f32_16x16x32_bf16 v[36:39], a[16:19], v[188:191], v[36:39]
    ds_read_b64_tr_b16 a[2:3], v2 offset:25856
    s_lshl_b32 s48, s48, 12
    s_add_u32 s62, s48, 0x20000
    s_waitcnt vmcnt(18)
    v_mfma_f32_16x16x32_bf16 v[52:55], a[16:19], v[204:207], v[52:55]
    s_add_u32 s50, s48, 0x40000
    buffer_load_dwordx4 v[120:123], v3, s[16:19], s48 offen offset:0
    s_waitcnt lgkmcnt(4)
    v_mfma_f32_16x16x32_bf16 v[24:27], a[20:23], v[172:175], v[24:27]
    ds_read_b64_tr_b16 a[4:5], v2 offset:25376
    buffer_load_dwordx4 v[136:139], v3, s[16:19], s62 offen offset:0
    v_mfma_f32_16x16x32_bf16 v[40:43], a[20:23], v[188:191], v[40:43]
    ds_read_b64_tr_b16 a[6:7], v2 offset:25888
    buffer_load_dwordx4 v[152:155], v3, s[16:19], s50 offen offset:0
    v_mfma_f32_16x16x32_bf16 v[56:59], a[20:23], v[204:207], v[56:59]
    buffer_load_dwordx4 v[124:127], v3, s[16:19], s48 offen offset:1024
    buffer_load_dwordx4 v[140:143], v3, s[16:19], s62 offen offset:1024
    v_mfma_f32_16x16x32_bf16 v[28:31], a[24:27], v[172:175], v[28:31]
    ds_read_b64_tr_b16 a[8:9], v2 offset:25408
    buffer_load_dwordx4 v[156:159], v3, s[16:19], s50 offen offset:1024
    v_mfma_f32_16x16x32_bf16 v[44:47], a[24:27], v[188:191], v[44:47]
    ds_read_b64_tr_b16 a[10:11], v2 offset:25920
    buffer_load_dwordx4 v[128:131], v3, s[16:19], s48 offen offset:2048
    v_mfma_f32_16x16x32_bf16 v[60:63], a[24:27], v[204:207], v[60:63]
    ds_read_b32 v71, v0 offset:80
    buffer_load_dwordx4 v[144:147], v3, s[16:19], s62 offen offset:2048
    s_waitcnt lgkmcnt(5)
    v_mfma_f32_16x16x32_bf16 v[32:35], a[28:31], v[172:175], v[32:35]
    ds_read_b64_tr_b16 a[12:13], v2 offset:25440
    buffer_load_dwordx4 v[160:163], v3, s[16:19], s50 offen offset:2048
    v_mfma_f32_16x16x32_bf16 v[48:51], a[28:31], v[188:191], v[48:51]
    ds_read_b64_tr_b16 a[14:15], v2 offset:25952
    buffer_load_dwordx4 v[132:135], v3, s[16:19], s48 offen offset:3072
    v_mfma_f32_16x16x32_bf16 v[64:67], a[28:31], v[204:207], v[64:67]
    buffer_load_dwordx4 v[148:151], v3, s[16:19], s62 offen offset:3072
    buffer_load_dwordx4 v[164:167], v3, s[16:19], s50 offen offset:3072
    s_waitcnt vmcnt(29)
    v_mfma_f32_16x16x32_bf16 v[20:23], a[0:3], v[176:179], v[20:23]
    ds_read_b64_tr_b16 a[16:17], v2 offset:29568
    s_waitcnt vmcnt(28)
    v_mfma_f32_16x16x32_bf16 v[36:39], a[0:3], v[192:195], v[36:39]
    ds_read_b64_tr_b16 a[18:19], v2 offset:30080
    s_waitcnt vmcnt(27)
    v_mfma_f32_16x16x32_bf16 v[52:55], a[0:3], v[208:211], v[52:55]
    s_waitcnt lgkmcnt(5)
    v_mfma_f32_16x16x32_bf16 v[24:27], a[4:7], v[176:179], v[24:27]
    ds_read_b64_tr_b16 a[20:21], v2 offset:29600
    v_mfma_f32_16x16x32_bf16 v[40:43], a[4:7], v[192:195], v[40:43]
    ds_read_b64_tr_b16 a[22:23], v2 offset:30112
    v_mfma_f32_16x16x32_bf16 v[56:59], a[4:7], v[208:211], v[56:59]
    v_mfma_f32_16x16x32_bf16 v[28:31], a[8:11], v[176:179], v[28:31]
    ds_read_b64_tr_b16 a[24:25], v2 offset:29632
    v_mfma_f32_16x16x32_bf16 v[44:47], a[8:11], v[192:195], v[44:47]
    ds_read_b64_tr_b16 a[26:27], v2 offset:30144
    v_mfma_f32_16x16x32_bf16 v[60:63], a[8:11], v[208:211], v[60:63]
    s_waitcnt lgkmcnt(6)
    v_mfma_f32_16x16x32_bf16 v[32:35], a[12:15], v[176:179], v[32:35]
    ds_read_b64_tr_b16 a[28:29], v2 offset:29664
    v_mfma_f32_16x16x32_bf16 v[48:51], a[12:15], v[192:195], v[48:51]
    ds_read_b64_tr_b16 a[30:31], v2 offset:30176
    v_mfma_f32_16x16x32_bf16 v[64:67], a[12:15], v[208:211], v[64:67]
    v_cmp_gt_u32 vcc, 3, v71
    s_cbranch_vccnz L_k_spin_pw3
L_k_ret_pw3:
    s_waitcnt vmcnt(26) lgkmcnt(4)
    v_mfma_f32_16x16x32_bf16 v[20:23], a[16:19], v[180:183], v[20:23]
    ds_read_b64_tr_b16 a[0:1], v2 offset:33792
    s_waitcnt vmcnt(25)
    v_mfma_f32_16x16x32_bf16 v[36:39], a[16:19], v[196:199], v[36:39]
    ds_read_b64_tr_b16 a[2:3], v2 offset:34304
    s_waitcnt vmcnt(24)
    v_mfma_f32_16x16x32_bf16 v[52:55], a[16:19], v[212:215], v[52:55]
    v_mfma_f32_16x16x32_bf16 v[24:27], a[20:23], v[180:183], v[24:27]
    ds_read_b64_tr_b16 a[4:5], v2 offset:33824
    v_mfma_f32_16x16x32_bf16 v[40:43], a[20:23], v[196:199], v[40:43]
    ds_read_b64_tr_b16 a[6:7], v2 offset:34336
    v_mfma_f32_16x16x32_bf16 v[56:59], a[20:23], v[212:215], v[56:59]
    s_waitcnt lgkmcnt(4)
    v_mfma_f32_16x16x32_bf16 v[28:31], a[24:27], v[180:183], v[28:31]
    ds_read_b64_tr_b16 a[8:9], v2 offset:33856
    v_mfma_f32_16x16x32_bf16 v[44:47], a[24:27], v[196:199], v[44:47]
    ds_read_b64_tr_b16 a[10:11], v2 offset:34368
    v_mfma_f32_16x16x32_bf16 v[60:63], a[24:27], v[212:215], v[60:63]
    v_mfma_f32_16x16x32_bf16 v[32:35], a[28:31], v[180:183], v[32:35]
    ds_read_b64_tr_b16 a[12:13], v2 offset:33888
    v_mfma_f32_16x16x32_bf16 v[48:51], a[28:31], v[196:199], v[48:51]
    ds_read_b64_tr_b16 a[14:15], v2 offset:34400
    v_mfma_f32_16x16x32_bf16 v[64:67], a[28:31], v[212:215], v[64:67]
    s_waitcnt vmcnt(23) lgkmcnt(4)
    v_mfma_f32_16x16x32_bf16 v[20:23], a[0:3], v[72:75], v[20:23]
    ds_read_b64_tr_b16 a[16:17], v2 offset:38016
    s_waitcnt vmcnt(22)
    v_mfma_f32_16x16x32_bf16 v[36:39], a[0:3], v[88:91], v[36:39]
    ds_read_b64_tr_b16 a[18:19], v2 offset:38528
    s_waitcnt vmcnt(21)
    v_mfma_f32_16x16x32_bf16 v[52:55], a[0:3], v[104:107], v[52:55]
    ds_read_b32 v70, v0 offset:112
    v_mfma_f32_16x16x32_bf16 v[24:27], a[4:7], v[72:75], v[24:27]
    ds_read_b64_tr_b16 a[20:21], v2 offset:38048
    v_mfma_f32_16x16x32_bf16 v[40:43], a[4:7], v[88:91], v[40:43]
    ds_read_b64_tr_b16 a[22:23], v2 offset:38560
    v_mfma_f32_16x16x32_bf16 v[56:59], a[4:7], v[104:107], v[56:59]
    s_waitcnt lgkmcnt(5)
    v_mfma_f32_16x16x32_bf16 v[28:31], a[8:11], v[72:75], v[28:31]
    ds_read_b64_tr_b16 a[24:25], v2 offset:38080
    v_mfma_f32_16x16x32_bf16 v[44:47], a[8:11], v[88:91], v[44:47]
    ds_read_b64_tr_b16 a[26:27], v2 offset:38592
    v_mfma_f32_16x16x32_bf16 v[60:63], a[8:11], v[104:107], v[60:63]
    v_mfma_f32_16x16x32_bf16 v[32:35], a[12:15], v[72:75], v[32:35]
    ds_read_b64_tr_b16 a[28:29], v2 offset:38112
    v_mfma_f32_16x16x32_bf16 v[48:51], a[12:15], v[88:91], v[48:51]
    ds_read_b64_tr_b16 a[30:31], v2 offset:38624
    v_mfma_f32_16x16x32_bf16 v[64:67], a[12:15], v[104:107], v[64:67]
    s_waitcnt lgkmcnt(6)
    v_cmp_gt_u32 vcc, 6, v70
    s_cbranch_vccnz L_k_spin_po4
L_k_ret_po4:
    s_waitcnt vmcnt(20)
    v_mfma_f32_16x16x32_bf16 v[20:23], a[16:19], v[76:79], v[20:23]
    ds_read_b64_tr_b16 a[0:1], v2 offset:42240
    s_add_u32 s48, s81, 6
    s_and_b32 s48, s48, 7
    s_waitcnt vmcnt(19)
    v_mfma_f32_16x16x32_bf16 v[36:39], a[16:19], v[92:95], v[36:39]
    ds_read_b64_tr_b16 a[2:3], v2 offset:42752
    s_lshl_b32 s48, s48, 12
    s_add_u32 s62, s48, 0x20000
    s_waitcnt vmcnt(18)
    v_mfma_f32_16x16x32_bf16 v[52:55], a[16:19], v[108:111], v[52:55]
    s_add_u32 s50, s48, 0x40000
    buffer_load_dwordx4 v[168:171], v3, s[16:19], s48 offen offset:0
    s_waitcnt lgkmcnt(4)
    v_mfma_f32_16x16x32_bf16 v[24:27], a[20:23], v[76:79], v[24:27]
    ds_read_b64_tr_b16 a[4:5], v2 offset:42272
    buffer_load_dwordx4 v[184:187], v3, s[16:19], s62 offen offset:0
    v_mfma_f32_16x16x32_bf16 v[40:43], a[20:23], v[92:95], v[40:43]
    ds_read_b64_tr_b16 a[6:7], v2 offset:42784
    buffer_load_dwordx4 v[200:203], v3, s[16:19], s50 offen offset:0
    v_mfma_f32_16x16x32_bf16 v[56:59], a[20:23], v[108:111], v[56:59]
    buffer_load_dwordx4 v[172:175], v3, s[16:19], s48 offen offset:1024
    buffer_load_dwordx4 v[188:191], v3, s[16:19], s62 offen offset:1024
    v_mfma_f32_16x16x32_bf16 v[28:31], a[24:27], v[76:79], v[28:31]
    ds_read_b64_tr_b16 a[8:9], v2 offset:42304
    buffer_load_dwordx4 v[204:207], v3, s[16:19], s50 offen offset:1024
    v_mfma_f32_16x16x32_bf16 v[44:47], a[24:27], v[92:95], v[44:47]
    ds_read_b64_tr_b16 a[10:11], v2 offset:42816
    buffer_load_dwordx4 v[176:179], v3, s[16:19], s48 offen offset:2048
    v_mfma_f32_16x16x32_bf16 v[60:63], a[24:27], v[108:111], v[60:63]
    ds_read_b32 v71, v0 offset:84
    buffer_load_dwordx4 v[192:195], v3, s[16:19], s62 offen offset:2048
    s_waitcnt lgkmcnt(5)
    v_mfma_f32_16x16x32_bf16 v[32:35], a[28:31], v[76:79], v[32:35]
    ds_read_b64_tr_b16 a[12:13], v2 offset:42336
    buffer_load_dwordx4 v[208:211], v3, s[16:19], s50 offen offset:2048
    v_mfma_f32_16x16x32_bf16 v[48:51], a[28:31], v[92:95], v[48:51]
    ds_read_b64_tr_b16 a[14:15], v2 offset:42848
    buffer_load_dwordx4 v[180:183], v3, s[16:19], s48 offen offset:3072
    v_mfma_f32_16x16x32_bf16 v[64:67], a[28:31], v[108:111], v[64:67]
    buffer_load_dwordx4 v[196:199], v3, s[16:19], s62 offen offset:3072
    buffer_load_dwordx4 v[212:215], v3, s[16:19], s50 offen offset:3072
    s_waitcnt vmcnt(29)
    v_mfma_f32_16x16x32_bf16 v[20:23], a[0:3], v[80:83], v[20:23]
    ds_read_b64_tr_b16 a[16:17], v2 offset:46464
    s_waitcnt vmcnt(28)
    v_mfma_f32_16x16x32_bf16 v[36:39], a[0:3], v[96:99], v[36:39]
    ds_read_b64_tr_b16 a[18:19], v2 offset:46976
    s_waitcnt vmcnt(27)
    v_mfma_f32_16x16x32_bf16 v[52:55], a[0:3], v[112:115], v[52:55]
    s_waitcnt lgkmcnt(5)
    v_mfma_f32_16x16x32_bf16 v[24:27], a[4:7], v[80:83], v[24:27]
    ds_read_b64_tr_b16 a[20:21], v2 offset:46496
    v_mfma_f32_16x16x32_bf16 v[40:43], a[4:7], v[96:99], v[40:43]
    ds_read_b64_tr_b16 a[22:23], v2 offset:47008
    v_mfma_f32_16x16x32_bf16 v[56:59], a[4:7], v[112:115], v[56:59]
    v_mfma_f32_16x16x32_bf16 v[28:31], a[8:11], v[80:83], v[28:31]
    ds_read_b64_tr_b16 a[24:25], v2 offset:46528
    v_mfma_f32_16x16x32_bf16 v[44:47], a[8:11], v[96:99], v[44:47]
    ds_read_b64_tr_b16 a[26:27], v2 offset:47040
    v_mfma_f32_16x16x32_bf16 v[60:63], a[8:11], v[112:115], v[60:63]
    s_waitcnt lgkmcnt(6)
    v_mfma_f32_16x16x32_bf16 v[32:35], a[12:15], v[80:83], v[32:35]
    ds_read_b64_tr_b16 a[28:29], v2 offset:46560
    v_mfma_f32_16x16x32_bf16 v[48:51], a[12:15], v[96:99], v[48:51]
    ds_read_b64_tr_b16 a[30:31], v2 offset:47072
    v_mfma_f32_16x16x32_bf16 v[64:67], a[12:15], v[112:115], v[64:67]
    v_cmp_gt_u32 vcc, 3, v71
    s_cbranch_vccnz L_k_spin_pw4
L_k_ret_pw4:
    s_waitcnt vmcnt(26) lgkmcnt(4)
    v_mfma_f32_16x16x32_bf16 v[20:23], a[16:19], v[84:87], v[20:23]
    ds_read_b64_tr_b16 a[0:1], v2 offset:50688
    s_waitcnt vmcnt(25)
    v_mfma_f32_16x16x32_bf16 v[36:39], a[16:19], v[100:103], v[36:39]
    ds_read_b64_tr_b16 a[2:3], v2 offset:51200
    s_waitcnt vmcnt(24)
    v_mfma_f32_16x16x32_bf16 v[52:55], a[16:19], v[116:119], v[52:55]
    v_mfma_f32_16x16x32_bf16 v[24:27], a[20:23], v[84:87], v[24:27]
    ds_read_b64_tr_b16 a[4:5], v2 offset:50720
    v_mfma_f32_16x16x32_bf16 v[40:43], a[20:23], v[100:103], v[40:43]
    ds_read_b64_tr_b16 a[6:7], v2 offset:51232
    v_mfma_f32_16x16x32_bf16 v[56:59], a[20:23], v[116:119], v[56:59]
    s_waitcnt lgkmcnt(4)
    v_mfma_f32_16x16x32_bf16 v[28:31], a[24:27], v[84:87], v[28:31]
    ds_read_b64_tr_b16 a[8:9], v2 offset:50752
    v_mfma_f32_16x16x32_bf16 v[44:47], a[24:27], v[100:103], v[44:47]
    ds_read_b64_tr_b16 a[10:11], v2 offset:51264
    v_mfma_f32_16x16x32_bf16 v[60:63], a[24:27], v[116:119], v[60:63]
    v_mfma_f32_16x16x32_bf16 v[32:35], a[28:31], v[84:87], v[32:35]
    ds_read_b64_tr_b16 a[12:13], v2 offset:50784
    v_mfma_f32_16x16x32_bf16 v[48:51], a[28:31], v[100:103], v[48:51]
    ds_read_b64_tr_b16 a[14:15], v2 offset:51296
    v_mfma_f32_16x16x32_bf16 v[64:67], a[28:31], v[116:119], v[64:67]
    s_waitcnt vmcnt(23) lgkmcnt(4)
    v_mfma_f32_16x16x32_bf16 v[20:23], a[0:3], v[120:123], v[20:23]
    ds_read_b64_tr_b16 a[16:17], v2 offset:54912
    s_waitcnt vmcnt(22)
    v_mfma_f32_16x16x32_bf16 v[36:39], a[0:3], v[136:139], v[36:39]
    ds_read_b64_tr_b16 a[18:19], v2 offset:55424
    s_waitcnt vmcnt(21)
    v_mfma_f32_16x16x32_bf16 v[52:55], a[0:3], v[152:155], v[52:55]
    ds_read_b32 v70, v0 offset:112
    v_mfma_f32_16x16x32_bf16 v[24:27], a[4:7], v[120:123], v[24:27]
    ds_read_b64_tr_b16 a[20:21], v2 offset:54944
    v_mfma_f32_16x16x32_bf16 v[40:43], a[4:7], v[136:139], v[40:43]
    ds_read_b64_tr_b16 a[22:23], v2 offset:55456
    v_mfma_f32_16x16x32_bf16 v[56:59], a[4:7], v[152:155], v[56:59]
    s_waitcnt lgkmcnt(5)
    v_mfma_f32_16x16x32_bf16 v[28:31], a[8:11], v[120:123], v[28:31]
    ds_read_b64_tr_b16 a[24:25], v2 offset:54976
    v_mfma_f32_16x16x32_bf16 v[44:47], a[8:11], v[136:139], v[44:47]
    ds_read_b64_tr_b16 a[26:27], v2 offset:55488
    v_mfma_f32_16x16x32_bf16 v[60:63], a[8:11], v[152:155], v[60:63]
    v_mfma_f32_16x16x32_bf16 v[32:35], a[12:15], v[120:123], v[32:35]
    ds_read_b64_tr_b16 a[28:29], v2 offset:55008
    v_mfma_f32_16x16x32_bf16 v[48:51], a[12:15], v[136:139], v[48:51]
    ds_read_b64_tr_b16 a[30:31], v2 offset:55520
    v_mfma_f32_16x16x32_bf16 v[64:67], a[12:15], v[152:155], v[64:67]
    s_waitcnt lgkmcnt(6)
    v_cmp_gt_u32 vcc, 7, v70
    s_cbranch_vccnz L_k_spin_po5
L_k_ret_po5:
    s_waitcnt vmcnt(20)
    v_mfma_f32_16x16x32_bf16 v[20:23], a[16:19], v[124:127], v[20:23]
    ds_read_b64_tr_b16 a[0:1], v2 offset:59136
    s_add_u32 s48, s81, 7
    s_and_b32 s48, s48, 7
    s_waitcnt vmcnt(19)
    v_mfma_f32_16x16x32_bf16 v[36:39], a[16:19], v[140:143], v[36:39]
    ds_read_b64_tr_b16 a[2:3], v2 offset:59648
    s_lshl_b32 s48, s48, 12
    s_add_u32 s62, s48, 0x20000
    s_waitcnt vmcnt(18)
    v_mfma_f32_16x16x32_bf16 v[52:55], a[16:19], v[156:159], v[52:55]
    s_add_u32 s50, s48, 0x40000
    buffer_load_dwordx4 v[72:75], v3, s[16:19], s48 offen offset:0
    s_waitcnt lgkmcnt(4)
    v_mfma_f32_16x16x32_bf16 v[24:27], a[20:23], v[124:127], v[24:27]
    ds_read_b64_tr_b16 a[4:5], v2 offset:59168
    buffer_load_dwordx4 v[88:91], v3, s[16:19], s62 offen offset:0
    v_mfma_f32_16x16x32_bf16 v[40:43], a[20:23], v[140:143], v[40:43]
    ds_read_b64_tr_b16 a[6:7], v2 offset:59680
    buffer_load_dwordx4 v[104:107], v3, s[16:19], s50 offen offset:0
    v_mfma_f32_16x16x32_bf16 v[56:59], a[20:23], v[156:159], v[56:59]
    buffer_load_dwordx4 v[76:79], v3, s[16:19], s48 offen offset:1024
    buffer_load_dwordx4 v[92:95], v3, s[16:19], s62 offen offset:1024
    v_mfma_f32_16x16x32_bf16 v[28:31], a[24:27], v[124:127], v[28:31]
    ds_read_b64_tr_b16 a[8:9], v2 offset:59200
    buffer_load_dwordx4 v[108:111], v3, s[16:19], s50 offen offset:1024
    v_mfma_f32_16x16x32_bf16 v[44:47], a[24:27], v[140:143], v[44:47]
    ds_read_b64_tr_b16 a[10:11], v2 offset:59712
    buffer_load_dwordx4 v[80:83], v3, s[16:19], s48 offen offset:2048
    v_mfma_f32_16x16x32_bf16 v[60:63], a[24:27], v[156:159], v[60:63]
    ds_read_b32 v71, v0 offset:80
    buffer_load_dwordx4 v[96:99], v3, s[16:19], s62 offen offset:2048
    s_waitcnt lgkmcnt(5)
    v_mfma_f32_16x16x32_bf16 v[32:35], a[28:31], v[124:127], v[32:35]
    ds_read_b64_tr_b16 a[12:13], v2 offset:59232
    buffer_load_dwordx4 v[112:115], v3, s[16:19], s50 offen offset:2048
    v_mfma_f32_16x16x32_bf16 v[48:51], a[28:31], v[140:143], v[48:51]
    ds_read_b64_tr_b16 a[14:15], v2 offset:59744
    buffer_load_dwordx4 v[84:87], v3, s[16:19], s48 offen offset:3072
    v_mfma_f32_16x16x32_bf16 v[64:67], a[28:31], v[156:159], v[64:67]
    buffer_load_dwordx4 v[100:103], v3, s[16:19], s62 offen offset:3072
    buffer_load_dwordx4 v[116:119], v3, s[16:19], s50 offen offset:3072
    s_waitcnt vmcnt(29)
    v_mfma_f32_16x16x32_bf16 v[20:23], a[0:3], v[128:131], v[20:23]
    ds_read_b64_tr_b16 a[16:17], v4 offset:1920
    s_waitcnt vmcnt(28)
    v_mfma_f32_16x16x32_bf16 v[36:39], a[0:3], v[144:147], v[36:39]
    ds_read_b64_tr_b16 a[18:19], v4 offset:2432
    s_waitcnt vmcnt(27)
    v_mfma_f32_16x16x32_bf16 v[52:55], a[0:3], v[160:163], v[52:55]
    s_waitcnt lgkmcnt(5)
    v_mfma_f32_16x16x32_bf16 v[24:27], a[4:7], v[128:131], v[24:27]
    ds_read_b64_tr_b16 a[20:21], v4 offset:1952
    v_mfma_f32_16x16x32_bf16 v[40:43], a[4:7], v[144:147], v[40:43]
    ds_read_b64_tr_b16 a[22:23], v4 offset:2464
    v_mfma_f32_16x16x32_bf16 v[56:59], a[4:7], v[160:163], v[56:59]
    v_mfma_f32_16x16x32_bf16 v[28:31], a[8:11], v[128:131], v[28:31]
    ds_read_b64_tr_b16 a[24:25], v4 offset:1984
    v_mfma_f32_16x16x32_bf16 v[44:47], a[8:11], v[144:147], v[44:47]
    ds_read_b64_tr_b16 a[26:27], v4 offset:2496
    v_mfma_f32_16x16x32_bf16 v[60:63], a[8:11], v[160:163], v[60:63]
    s_waitcnt lgkmcnt(6)
    v_mfma_f32_16x16x32_bf16 v[32:35], a[12:15], v[128:131], v[32:35]
    ds_read_b64_tr_b16 a[28:29], v4 offset:2016
    v_mfma_f32_16x16x32_bf16 v[48:51], a[12:15], v[144:147], v[48:51]
    ds_read_b64_tr_b16 a[30:31], v4 offset:2528
    v_mfma_f32_16x16x32_bf16 v[64:67], a[12:15], v[160:163], v[64:67]
    v_cmp_gt_u32 vcc, 4, v71
    s_cbranch_vccnz L_k_spin_pw5
L_k_ret_pw5:
    s_waitcnt vmcnt(26) lgkmcnt(4)
    v_mfma_f32_16x16x32_bf16 v[20:23], a[16:19], v[132:135], v[20:23]
    ds_read_b64_tr_b16 a[0:1], v4 offset:6144
    s_waitcnt vmcnt(25)
    v_mfma_f32_16x16x32_bf16 v[36:39], a[16:19], v[148:151], v[36:39]
    ds_read_b64_tr_b16 a[2:3], v4 offset:6656
    s_waitcnt vmcnt(24)
    v_mfma_f32_16x16x32_bf16 v[52:55], a[16:19], v[164:167], v[52:55]
    v_mfma_f32_16x16x32_bf16 v[24:27], a[20:23], v[132:135], v[24:27]
    ds_read_b64_tr_b16 a[4:5], v4 offset:6176
    v_mfma_f32_16x16x32_bf16 v[40:43], a[20:23], v[148:151], v[40:43]
    ds_read_b64_tr_b16 a[6:7], v4 offset:6688
    v_mfma_f32_16x16x32_bf16 v[56:59], a[20:23], v[164:167], v[56:59]
    s_waitcnt lgkmcnt(4)
    v_mfma_f32_16x16x32_bf16 v[28:31], a[24:27], v[132:135], v[28:31]
    ds_read_b64_tr_b16 a[8:9], v4 offset:6208
    v_mfma_f32_16x16x32_bf16 v[44:47], a[24:27], v[148:151], v[44:47]
    ds_read_b64_tr_b16 a[10:11], v4 offset:6720
    v_mfma_f32_16x16x32_bf16 v[60:63], a[24:27], v[164:167], v[60:63]
    v_mfma_f32_16x16x32_bf16 v[32:35], a[28:31], v[132:135], v[32:35]
    ds_read_b64_tr_b16 a[12:13], v4 offset:6240
    v_mfma_f32_16x16x32_bf16 v[48:51], a[28:31], v[148:151], v[48:51]
    ds_read_b64_tr_b16 a[14:15], v4 offset:6752
    v_mfma_f32_16x16x32_bf16 v[64:67], a[28:31], v[164:167], v[64:67]
    s_waitcnt vmcnt(23) lgkmcnt(4)
    v_mfma_f32_16x16x32_bf16 v[20:23], a[0:3], v[168:171], v[20:23]
    ds_read_b64_tr_b16 a[16:17], v4 offset:10368
    s_waitcnt vmcnt(22)
    v_mfma_f32_16x16x32_bf16 v[36:39], a[0:3], v[184:187], v[36:39]
    ds_read_b64_tr_b16 a[18:19], v4 offset:10880
    s_waitcnt vmcnt(21)
    v_mfma_f32_16x16x32_bf16 v[52:55], a[0:3], v[200:203], v[52:55]
    v_mfma_f32_16x16x32_bf16 v[24:27], a[4:7], v[168:171], v[24:27]
    ds_read_b64_tr_b16 a[20:21], v4 offset:10400
    v_mfma_f32_16x16x32_bf16 v[40:43], a[4:7], v[184:187], v[40:43]
    ds_read_b64_tr_b16 a[22:23], v4 offset:10912
    v_mfma_f32_16x16x32_bf16 v[56:59], a[4:7], v[200:203], v[56:59]
    s_waitcnt lgkmcnt(4)
    v_mfma_f32_16x16x32_bf16 v[28:31], a[8:11], v[168:171], v[28:31]
    ds_read_b64_tr_b16 a[24:25], v4 offset:10432
    v_mfma_f32_16x16x32_bf16 v[44:47], a[8:11], v[184:187], v[44:47]
    ds_read_b64_tr_b16 a[26:27], v4 offset:10944
    v_mfma_f32_16x16x32_bf16 v[60:63], a[8:11], v[200:203], v[60:63]
    v_mfma_f32_16x16x32_bf16 v[32:35], a[12:15], v[168:171], v[32:35]
    ds_read_b64_tr_b16 a[28:29], v4 offset:10464
    v_mfma_f32_16x16x32_bf16 v[48:51], a[12:15], v[184:187], v[48:51]
    ds_read_b64_tr_b16 a[30:31], v4 offset:10976
    v_mfma_f32_16x16x32_bf16 v[64:67], a[12:15], v[200:203], v[64:67]
    s_waitcnt vmcnt(20) lgkmcnt(4)
    v_mfma_f32_16x16x32_bf16 v[20:23], a[16:19], v[172:175], v[20:23]
    ds_read_b64_tr_b16 a[0:1], v4 offset:14592
    s_waitcnt vmcnt(19)
    v_mfma_f32_16x16x32_bf16 v[36:39], a[16:19], v[188:191], v[36:39]
    ds_read_b64_tr_b16 a[2:3], v4 offset:15104
    s_waitcnt vmcnt(18)
    v_mfma_f32_16x16x32_bf16 v[52:55], a[16:19], v[204:207], v[52:55]
    v_mfma_f32_16x16x32_bf16 v[24:27], a[20:23], v[172:175], v[24:27]
    ds_read_b64_tr_b16 a[4:5], v4 offset:14624
    v_mfma_f32_16x16x32_bf16 v[40:43], a[20:23], v[188:191], v[40:43]
    ds_read_b64_tr_b16 a[6:7], v4 offset:15136
    v_mfma_f32_16x16x32_bf16 v[56:59], a[20:23], v[204:207], v[56:59]
    s_waitcnt lgkmcnt(4)
    v_mfma_f32_16x16x32_bf16 v[28:31], a[24:27], v[172:175], v[28:31]
    ds_read_b64_tr_b16 a[8:9], v4 offset:14656
    v_mfma_f32_16x16x32_bf16 v[44:47], a[24:27], v[188:191], v[44:47]
    ds_read_b64_tr_b16 a[10:11], v4 offset:15168
    v_mfma_f32_16x16x32_bf16 v[60:63], a[24:27], v[204:207], v[60:63]
    ds_read_b32 v71, v0 offset:84
    v_mfma_f32_16x16x32_bf16 v[32:35], a[28:31], v[172:175], v[32:35]
    ds_read_b64_tr_b16 a[12:13], v4 offset:14688
    v_mfma_f32_16x16x32_bf16 v[48:51], a[28:31], v[188:191], v[48:51]
    ds_read_b64_tr_b16 a[14:15], v4 offset:15200
    v_mfma_f32_16x16x32_bf16 v[64:67], a[28:31], v[204:207], v[64:67]
    s_waitcnt vmcnt(17) lgkmcnt(5)
    v_mfma_f32_16x16x32_bf16 v[20:23], a[0:3], v[176:179], v[20:23]
    ds_read_b64_tr_b16 a[16:17], v4 offset:18816
    s_waitcnt vmcnt(16)
    v_mfma_f32_16x16x32_bf16 v[36:39], a[0:3], v[192:195], v[36:39]
    ds_read_b64_tr_b16 a[18:19], v4 offset:19328
    s_waitcnt vmcnt(15)
    v_mfma_f32_16x16x32_bf16 v[52:55], a[0:3], v[208:211], v[52:55]
    v_mfma_f32_16x16x32_bf16 v[24:27], a[4:7], v[176:179], v[24:27]
    ds_read_b64_tr_b16 a[20:21], v4 offset:18848
    v_mfma_f32_16x16x32_bf16 v[40:43], a[4:7], v[192:195], v[40:43]
    ds_read_b64_tr_b16 a[22:23], v4 offset:19360
    v_mfma_f32_16x16x32_bf16 v[56:59], a[4:7], v[208:211], v[56:59]
    s_waitcnt lgkmcnt(4)
    v_mfma_f32_16x16x32_bf16 v[28:31], a[8:11], v[176:179], v[28:31]
    ds_read_b64_tr_b16 a[24:25], v4 offset:18880
    v_mfma_f32_16x16x32_bf16 v[44:47], a[8:11], v[192:195], v[44:47]
    ds_read_b64_tr_b16 a[26:27], v4 offset:19392
    v_mfma_f32_16x16x32_bf16 v[60:63], a[8:11], v[208:211], v[60:63]
    v_mfma_f32_16x16x32_bf16 v[32:35], a[12:15], v[176:179], v[32:35]
    ds_read_b64_tr_b16 a[28:29], v4 offset:18912
    v_mfma_f32_16x16x32_bf16 v[48:51], a[12:15], v[192:195], v[48:51]
    ds_read_b64_tr_b16 a[30:31], v4 offset:19424
    v_mfma_f32_16x16x32_bf16 v[64:67], a[12:15], v[208:211], v[64:67]
    v_cmp_gt_u32 vcc, 4, v71
    s_cbranch_vccnz L_k_spin_pw6
L_k_ret_pw6:
    s_waitcnt vmcnt(14) lgkmcnt(4)
    v_mfma_f32_16x16x32_bf16 v[20:23], a[16:19], v[180:183], v[20:23]
    ds_read_b64_tr_b16 a[0:1], v4 offset:23040
    s_waitcnt vmcnt(13)
    v_mfma_f32_16x16x32_bf16 v[36:39], a[16:19], v[196:199], v[36:39]
    ds_read_b64_tr_b16 a[2:3], v4 offset:23552
    s_waitcnt vmcnt(12)
    v_mfma_f32_16x16x32_bf16 v[52:55], a[16:19], v[212:215], v[52:55]
    v_mfma_f32_16x16x32_bf16 v[24:27], a[20:23], v[180:183], v[24:27]
    ds_read_b64_tr_b16 a[4:5], v4 offset:23072
    v_mfma_f32_16x16x32_bf16 v[40:43], a[20:23], v[196:199], v[40:43]
    ds_read_b64_tr_b16 a[6:7], v4 offset:23584
    v_mfma_f32_16x16x32_bf16 v[56:59], a[20:23], v[212:215], v[56:59]
    s_waitcnt lgkmcnt(4)
    v_mfma_f32_16x16x32_bf16 v[28:31], a[24:27], v[180:183], v[28:31]
    ds_read_b64_tr_b16 a[8:9], v4 offset:23104
    v_mfma_f32_16x16x32_bf16 v[44:47], a[24:27], v[196:199], v[44:47]
    ds_read_b64_tr_b16 a[10:11], v4 offset:23616
    v_mfma_f32_16x16x32_bf16 v[60:63], a[24:27], v[212:215], v[60:63]
    v_mfma_f32_16x16x32_bf16 v[32:35], a[28:31], v[180:183], v[32:35]
    ds_read_b64_tr_b16 a[12:13], v4 offset:23136
    v_mfma_f32_16x16x32_bf16 v[48:51], a[28:31], v[196:199], v[48:51]
    ds_read_b64_tr_b16 a[14:15], v4 offset:23648
    v_mfma_f32_16x16x32_bf16 v[64:67], a[28:31], v[212:215], v[64:67]
    s_waitcnt vmcnt(11) lgkmcnt(4)
    v_mfma_f32_16x16x32_bf16 v[20:23], a[0:3], v[72:75], v[20:23]
    ds_read_b64_tr_b16 a[16:17], v4 offset:27264
    s_waitcnt vmcnt(10)
    v_mfma_f32_16x16x32_bf16 v[36:39], a[0:3], v[88:91], v[36:39]
    ds_read_b64_tr_b16 a[18:19], v4 offset:27776
    s_waitcnt vmcnt(9)
    v_mfma_f32_16x16x32_bf16 v[52:55], a[0:3], v[104:107], v[52:55]
    v_mfma_f32_16x16x32_bf16 v[24:27], a[4:7], v[72:75], v[24:27]
    ds_read_b64_tr_b16 a[20:21], v4 offset:27296
    v_mfma_f32_16x16x32_bf16 v[40:43], a[4:7], v[88:91], v[40:43]
    ds_read_b64_tr_b16 a[22:23], v4 offset:27808
    v_mfma_f32_16x16x32_bf16 v[56:59], a[4:7], v[104:107], v[56:59]
    s_waitcnt lgkmcnt(4)
    v_mfma_f32_16x16x32_bf16 v[28:31], a[8:11], v[72:75], v[28:31]
    ds_read_b64_tr_b16 a[24:25], v4 offset:27328
    v_mfma_f32_16x16x32_bf16 v[44:47], a[8:11], v[88:91], v[44:47]
    ds_read_b64_tr_b16 a[26:27], v4 offset:27840
    v_mfma_f32_16x16x32_bf16 v[60:63], a[8:11], v[104:107], v[60:63]
    v_mfma_f32_16x16x32_bf16 v[32:35], a[12:15], v[72:75], v[32:35]
    ds_read_b64_tr_b16 a[28:29], v4 offset:27360
    v_mfma_f32_16x16x32_bf16 v[48:51], a[12:15], v[88:91], v[48:51]
    ds_read_b64_tr_b16 a[30:31], v4 offset:27872
    v_mfma_f32_16x16x32_bf16 v[64:67], a[12:15], v[104:107], v[64:67]
    s_waitcnt vmcnt(8) lgkmcnt(4)
    v_mfma_f32_16x16x32_bf16 v[20:23], a[16:19], v[76:79], v[20:23]
    ds_read_b64_tr_b16 a[0:1], v4 offset:31488
    s_waitcnt vmcnt(7)
    v_mfma_f32_16x16x32_bf16 v[36:39], a[16:19], v[92:95], v[36:39]
    ds_read_b64_tr_b16 a[2:3], v4 offset:32000
    s_waitcnt vmcnt(6)
    v_mfma_f32_16x16x32_bf16 v[52:55], a[16:19], v[108:111], v[52:55]
    v_mfma_f32_16x16x32_bf16 v[24:27], a[20:23], v[76:79], v[24:27]
    ds_read_b64_tr_b16 a[4:5], v4 offset:31520
    v_mfma_f32_16x16x32_bf16 v[40:43], a[20:23], v[92:95], v[40:43]
    ds_read_b64_tr_b16 a[6:7], v4 offset:32032
    v_mfma_f32_16x16x32_bf16 v[56:59], a[20:23], v[108:111], v[56:59]
    s_waitcnt lgkmcnt(4)
    v_mfma_f32_16x16x32_bf16 v[28:31], a[24:27], v[76:79], v[28:31]
    ds_read_b64_tr_b16 a[8:9], v4 offset:31552
    v_mfma_f32_16x16x32_bf16 v[44:47], a[24:27], v[92:95], v[44:47]
    ds_read_b64_tr_b16 a[10:11], v4 offset:32064
    v_mfma_f32_16x16x32_bf16 v[60:63], a[24:27], v[108:111], v[60:63]
    v_mfma_f32_16x16x32_bf16 v[32:35], a[28:31], v[76:79], v[32:35]
    ds_read_b64_tr_b16 a[12:13], v4 offset:31584
    v_mfma_f32_16x16x32_bf16 v[48:51], a[28:31], v[92:95], v[48:51]
    ds_read_b64_tr_b16 a[14:15], v4 offset:32096
    v_mfma_f32_16x16x32_bf16 v[64:67], a[28:31], v[108:111], v[64:67]
    s_waitcnt vmcnt(5) lgkmcnt(4)
    v_mfma_f32_16x16x32_bf16 v[20:23], a[0:3], v[80:83], v[20:23]
    ds_read_b64_tr_b16 a[16:17], v4 offset:35712
    s_waitcnt vmcnt(4)
    v_mfma_f32_16x16x32_bf16 v[36:39], a[0:3], v[96:99], v[36:39]
    ds_read_b64_tr_b16 a[18:19], v4 offset:36224
    s_waitcnt vmcnt(3)
    v_mfma_f32_16x16x32_bf16 v[52:55], a[0:3], v[112:115], v[52:55]
    v_mfma_f32_16x16x32_bf16 v[24:27], a[4:7], v[80:83], v[24:27]
    ds_read_b64_tr_b16 a[20:21], v4 offset:35744
    v_mfma_f32_16x16x32_bf16 v[40:43], a[4:7], v[96:99], v[40:43]
    ds_read_b64_tr_b16 a[22:23], v4 offset:36256
    v_mfma_f32_16x16x32_bf16 v[56:59], a[4:7], v[112:115], v[56:59]
    s_waitcnt lgkmcnt(4)
    v_mfma_f32_16x16x32_bf16 v[28:31], a[8:11], v[80:83], v[28:31]
    ds_read_b64_tr_b16 a[24:25], v4 offset:35776
    v_mfma_f32_16x16x32_bf16 v[44:47], a[8:11], v[96:99], v[44:47]
    ds_read_b64_tr_b16 a[26:27], v4 offset:36288
    v_mfma_f32_16x16x32_bf16 v[60:63], a[8:11], v[112:115], v[60:63]
    v_mfma_f32_16x16x32_bf16 v[32:35], a[12:15], v[80:83], v[32:35]
    ds_read_b64_tr_b16 a[28:29], v4 offset:35808
    v_mfma_f32_16x16x32_bf16 v[48:51], a[12:15], v[96:99], v[48:51]
    ds_read_b64_tr_b16 a[30:31], v4 offset:36320
    v_mfma_f32_16x16x32_bf16 v[64:67], a[12:15], v[112:115], v[64:67]
    s_waitcnt vmcnt(2) lgkmcnt(4)
    v_mfma_f32_16x16x32_bf16 v[20:23], a[16:19], v[84:87], v[20:23]
    s_waitcnt vmcnt(1)
    v_mfma_f32_16x16x32_bf16 v[36:39], a[16:19], v[100:103], v[36:39]
    s_waitcnt vmcnt(0)
    v_mfma_f32_16x16x32_bf16 v[52:55], a[16:19], v[116:119], v[52:55]
    v_mfma_f32_16x16x32_bf16 v[24:27], a[20:23], v[84:87], v[24:27]
    v_mfma_f32_16x16x32_bf16 v[40:43], a[20:23], v[100:103], v[40:43]
    v_mfma_f32_16x16x32_bf16 v[56:59], a[20:23], v[116:119], v[56:59]
    s_waitcnt lgkmcnt(2)
    v_mfma_f32_16x16x32_bf16 v[28:31], a[24:27], v[84:87], v[28:31]
    v_mfma_f32_16x16x32_bf16 v[44:47], a[24:27], v[100:103], v[44:47]
    v_mfma_f32_16x16x32_bf16 v[60:63], a[24:27], v[116:119], v[60:63]
    s_waitcnt lgkmcnt(0)
    v_mfma_f32_16x16x32_bf16 v[32:35], a[28:31], v[84:87], v[32:35]
    v_mfma_f32_16x16x32_bf16 v[48:51], a[28:31], v[100:103], v[48:51]
    v_mfma_f32_16x16x32_bf16 v[64:67], a[28:31], v[116:119], v[64:67]
    v_lshlrev_b32 v5, 4, v1
    s_mul_i32 s47, s82, 0xd000
    s_mul_i32 s48, s44, 0x3000
    s_add_u32 s47, s47, s48
    buffer_store_dwordx4 v[20:23], v5, s[20:23], s47 offen offset:0 sc1
    buffer_store_dwordx4 v[24:27], v5, s[20:23], s47 offen offset:1024 sc1
    buffer_store_dwordx4 v[28:31], v5, s[20:23], s47 offen offset:2048 sc1
    buffer_store_dwordx4 v[32:35], v5, s[20:23], s47 offen offset:3072 sc1
    s_add_u32 s47, s47, 0x1000
    buffer_store_dwordx4 v[36:39], v5, s[20:23], s47 offen offset:0 sc1
    buffer_store_dwordx4 v[40:43], v5, s[20:23], s47 offen offset:1024 sc1
    buffer_store_dwordx4 v[44:47], v5, s[20:23], s47 offen offset:2048 sc1
    buffer_store_dwordx4 v[48:51], v5, s[20:23], s47 offen offset:3072 sc1
    s_add_u32 s47, s47, 0x1000
    buffer_store_dwordx4 v[52:55], v5, s[20:23], s47 offen offset:0 sc1
    buffer_store_dwordx4 v[56:59], v5, s[20:23], s47 offen offset:1024 sc1
    buffer_store_dwordx4 v[60:63], v5, s[20:23], s47 offen offset:2048 sc1
    buffer_store_dwordx4 v[64:67], v5, s[20:23], s47 offen offset:3072 sc1
    s_add_u32 s47, s47, 0x1000
    s_lshl_b32 s47, s82, 2
    s_add_u32 s49, s47, s84
    s_waitcnt vmcnt(0)
    v_mov_b32 v5, 1
    s_mov_b64 exec, 1
    ds_add_rtn_u32 v6, v0, v5 offset:100
    s_waitcnt lgkmcnt(0)
    v_cmp_eq_u32 vcc, 7, v6
    s_cbranch_vccz L_k_arr_c2
L_k_poll_noncec2:
    ds_read_b32 v5, v0 offset:116
    s_waitcnt lgkmcnt(0)
    v_cmp_gt_u32 vcc, 1, v5
    s_cbranch_vccz L_k_pok_noncec2
    s_sleep 1
    s_sub_u32 s80, s80, 1
    s_cbranch_scc0 L_k_poll_noncec2
    s_endpgm
L_k_pok_noncec2:
    v_mov_b32 v6, s49
    buffer_store_dword v5, v6, s[72:75], 0 offen sc1
L_k_arr_c2:
    s_mov_b64 exec, -1
    v_lshlrev_b32 v5, 4, v1
    v_and_b32 v6, 15, v1
    v_lshlrev_b32 v6, 10, v6
    v_lshrrev_b32 v72, 4, v1
    v_lshl_add_u32 v6, v72, 3, v6
    s_mul_i32 s47, s82, 12
    s_add_u32 s47, s47, s44
    s_lshl_b32 s48, s47, 10
    s_add_u32 s49, s48, 0x2000
    s_cmp_lt_u32 s44, 4
    s_cselect_b32 s50, 1, 0
    s_cmp_eq_u32 s82, 3
    s_cselect_b32 s50, 1, s50
    s_cmp_eq_u32 s50, 1
    s_cselect_b32 s49, s49, 0x40000000
L_k_poll_goc:
    ds_read_b32 v72, v0 offset:108
    s_waitcnt lgkmcnt(0)
    v_cmp_gt_u32 vcc, 1, v72
    s_cbranch_vccz L_k_pok_goc
    s_sleep 1
    s_sub_u32 s80, s80, 1
    s_cbranch_scc0 L_k_poll_goc
    s_endpgm
L_k_pok_goc:
    s_add_u32 s62, s48, 0
    buffer_load_dwordx4 v[72:75], v5, s[20:23], s62 offen sc1
    s_add_u32 s62, s48, 0xd000
    buffer_load_dwordx4 v[76:79], v5, s[20:23], s62 offen sc1
    s_add_u32 s62, s48, 0x1a000
    buffer_load_dwordx4 v[80:83], v5, s[20:23], s62 offen sc1
    s_add_u32 s62, s48, 0x27000
    buffer_load_dwordx4 v[84:87], v5, s[20:23], s62 offen sc1
    s_add_u32 s62, s49, 0
    buffer_load_dwordx4 v[88:91], v5, s[20:23], s62 offen sc1
    s_add_u32 s62, s49, 0xd000
    buffer_load_dwordx4 v[92:95], v5, s[20:23], s62 offen sc1
    s_add_u32 s62, s49, 0x1a000
    buffer_load_dwordx4 v[96:99], v5, s[20:23], s62 offen sc1
    s_add_u32 s62, s49, 0x27000
    buffer_load_dwordx4 v[100:103], v5, s[20:23], s62 offen sc1
    s_waitcnt vmcnt(6)
    v_add_f32 v72, v72, v76
    s_waitcnt vmcnt(4)
    v_add_f32 v80, v80, v84
    v_add_f32 v73, v73, v77
    v_add_f32 v81, v81, v85
    v_add_f32 v74, v74, v78
    v_add_f32 v82, v82, v86
    v_add_f32 v75, v75, v79
    v_add_f32 v83, v83, v87
    v_add_f32 v72, v72, v80
    v_add_f32 v73, v73, v81
    v_add_f32 v74, v74, v82
    v_add_f32 v75, v75, v83
    v_cvt_pk_bf16_f32 v72, v72, v73
    v_cvt_pk_bf16_f32 v73, v74, v75
    s_lshr_b32 s48, s47, 2
    s_lshl_b32 s48, s48, 14
    s_and_b32 s62, s47, 3
    s_lshl_b32 s62, s62, 5
    s_add_u32 s62, s62, s48
    buffer_store_dwordx2 v[72:73], v6, s[24:27], s62 offen
    s_waitcnt vmcnt(3)
    v_add_f32 v88, v88, v92
    s_waitcnt vmcnt(1)
    v_add_f32 v96, v96, v100
    v_add_f32 v89, v89, v93
    v_add_f32 v97, v97, v101
    v_add_f32 v90, v90, v94
    v_add_f32 v98, v98, v102
    v_add_f32 v91, v91, v95
    v_add_f32 v99, v99, v103
    v_add_f32 v88, v88, v96
    v_add_f32 v89, v89, v97
    v_add_f32 v90, v90, v98
    v_add_f32 v91, v91, v99
    v_cvt_pk_bf16_f32 v88, v88, v89
    v_cvt_pk_bf16_f32 v89, v90, v91
    s_add_u32 s47, s47, 8
    s_lshr_b32 s48, s47, 2
    s_lshl_b32 s48, s48, 14
    s_and_b32 s62, s47, 3
    s_lshl_b32 s62, s62, 5
    s_add_u32 s62, s62, s48
    s_cmp_eq_u32 s50, 1
    s_cselect_b32 s62, s62, 0x40000000
    buffer_store_dwordx2 v[88:89], v6, s[24:27], s62 offen
    s_endpgm
L_k_helper:
    s_cmp_ge_u32 s60, 2
    s_cbranch_scc1 L_k_h23
    v_and_b32 v5, 7, v1
    v_lshlrev_b32 v5, 4, v5
    v_lshrrev_b32 v6, 3, v1
    v_lshl_add_u32 v29, v6, 12, v5
    v_lshl_add_u32 v21, v6, 11, v5
    v_add_u32 v26, 0x60, v29
    v_add_u32 v27, 64, v29
    v_add_u32 v28, 32, v29
    v_add_u32 v21, 0x30040, v21
    v_add_u32 v20, 32, v21
    v_and_b32 v5, 15, v1
    v_lshlrev_b32 v5, 4, v5
    v_bfe_u32 v6, v1, 4, 1
    v_lshl_add_u32 v5, v6, 15, v5
    v_lshrrev_b32 v6, 5, v1
    v_lshl_add_u32 v22, v6, 17, v5
    v_add_u32 v23, 0x1be0, v22
    v_add_u32 v24, 0x37c0, v22
    v_add_u32 v25, 0x53a0, v22
    s_lshl_b32 s47, s76, 2
    s_add_u32 s47, s47, 0x26280
    v_mov_b32 v16, s47
    s_waitcnt lgkmcnt(0)
    s_mul_i32 s47, s45, 0x34000
    s_add_u32 s8, s28, s47
    s_addc_u32 s9, s29, 0
    s_sub_u32 s8, s8, 0x60
    s_subb_u32 s9, s9, 0
    s_mov_b32 s10, 0x34060
    s_mov_b32 s11, 0x20000
    s_lshl_b32 s47, s46, 8
    s_add_u32 s12, s34, s47
    s_addc_u32 s13, s35, 0
    s_sub_u32 s14, 0x400000, s47
    s_mov_b32 s15, 0x20000
    s_cmp_eq_u32 s76, 0
    s_cbranch_scc0 L_k_f1
    s_add_u32 s62, s78, 0
    s_and_b32 s62, s62, 7
    s_lshl_b32 s62, s62, 19
    s_mov_b32 m0, 0x15a80
    s_add_u32 s47, s62, 0
    buffer_load_dwordx4 v22, s[12:15], s47 offen offset:0 lds
    buffer_load_dwordx4 v23, s[12:15], s47 offen offset:1056 lds
    buffer_load_dwordx4 v24, s[12:15], s47 offen offset:2112 lds
    buffer_load_dwordx4 v25, s[12:15], s47 offen offset:3168 lds
    s_mov_b32 m0, 0x16b00
    s_add_u32 s47, s62, 0x10000
    buffer_load_dwordx4 v22, s[12:15], s47 offen offset:0 lds
    buffer_load_dwordx4 v23, s[12:15], s47 offen offset:1056 lds
    buffer_load_dwordx4 v24, s[12:15], s47 offen offset:2112 lds
    buffer_load_dwordx4 v25, s[12:15], s47 offen offset:3168 lds
    s_add_u32 s62, s78, 0
    s_and_b32 s62, s62, 7
    s_lshl_b32 s62, s62, 7
    s_mov_b32 m0, 0
    s_add_u32 s47, s62, 0
    buffer_load_dwordx4 v26, s[8:11], s47 offen offset:0 lds
    buffer_load_dwordx4 v27, s[8:11], s47 offen offset:1056 lds
    buffer_load_dwordx4 v28, s[8:11], s47 offen offset:2112 lds
    buffer_load_dwordx4 v29, s[8:11], s47 offen offset:3168 lds
    s_mov_b32 m0, 0x1080
    s_add_u32 s47, s62, 0x8000
    buffer_load_dwordx4 v26, s[8:11], s47 offen offset:0 lds
    buffer_load_dwordx4 v27, s[8:11], s47 offen offset:1056 lds
    buffer_load_dwordx4 v28, s[8:11], s47 offen offset:2112 lds
    buffer_load_dwordx4 v29, s[8:11], s47 offen offset:3168 lds
    s_mov_b32 m0, 0x2100
    s_add_u32 s47, s62, 0x10000
    buffer_load_dwordx4 v26, s[8:11], s47 offen offset:0 lds
    buffer_load_dwordx4 v27, s[8:11], s47 offen offset:1056 lds
    buffer_load_dwordx4 v28, s[8:11], s47 offen offset:2112 lds
    buffer_load_dwordx4 v29, s[8:11], s47 offen offset:3168 lds
    s_mov_b32 m0, 0x3180
    s_add_u32 s47, s62, 0x18000
    buffer_load_dwordx4 v26, s[8:11], s47 offen offset:0 lds
    buffer_load_dwordx4 v27, s[8:11], s47 offen offset:1056 lds
    buffer_load_dwordx4 v28, s[8:11], s47 offen offset:2112 lds
    buffer_load_dwordx4 v29, s[8:11], s47 offen offset:3168 lds
    s_mov_b32 m0, 0x4200
    s_add_u32 s47, s62, 0x20000
    buffer_load_dwordx4 v26, s[8:11], s47 offen offset:0 lds
    buffer_load_dwordx4 v27, s[8:11], s47 offen offset:1056 lds
    buffer_load_dwordx4 v28, s[8:11], s47 offen offset:2112 lds
    buffer_load_dwordx4 v29, s[8:11], s47 offen offset:3168 lds
    s_mov_b32 m0, 0x5280
    s_add_u32 s47, s62, 0x28000
    buffer_load_dwordx4 v26, s[8:11], s47 offen offset:0 lds
    buffer_load_dwordx4 v27, s[8:11], s47 offen offset:1056 lds
    buffer_load_dwordx4 v28, s[8:11], s47 offen offset:2112 lds
    buffer_load_dwordx4 v29, s[8:11], s47 offen offset:3168 lds
    s_mov_b32 m0, 0x6300
    s_nop 0
    buffer_load_dwordx4 v20, s[8:11], s62 offen offset:0 lds
    buffer_load_dwordx4 v21, s[8:11], s62 offen offset:1056 lds
    s_barrier
    s_waitcnt vmcnt(0)
    v_mov_b32 v17, 1
    ds_write_b32 v16, v17
    s_add_u32 s62, s78, 1
    s_and_b32 s62, s62, 7
    s_lshl_b32 s62, s62, 19
    s_add_u32 s62, s62, 0x40000
    s_mov_b32 m0, 0x1bd80
    s_add_u32 s47, s62, 0
    buffer_load_dwordx4 v22, s[12:15], s47 offen offset:0 lds
    buffer_load_dwordx4 v23, s[12:15], s47 offen offset:1056 lds
    buffer_load_dwordx4 v24, s[12:15], s47 offen offset:2112 lds
    buffer_load_dwordx4 v25, s[12:15], s47 offen offset:3168 lds
    s_mov_b32 m0, 0x1ce00
    s_add_u32 s47, s62, 0x10000
    buffer_load_dwordx4 v22, s[12:15], s47 offen offset:0 lds
    buffer_load_dwordx4 v23, s[12:15], s47 offen offset:1056 lds
    buffer_load_dwordx4 v24, s[12:15], s47 offen offset:2112 lds
    buffer_load_dwordx4 v25, s[12:15], s47 offen offset:3168 lds
    s_add_u32 s62, s78, 2
    s_and_b32 s62, s62, 7
    s_lshl_b32 s62, s62, 19
    s_mov_b32 m0, 0x1de80
    s_add_u32 s47, s62, 0
    buffer_load_dwordx4 v22, s[12:15], s47 offen offset:0 lds
    buffer_load_dwordx4 v23, s[12:15], s47 offen offset:1056 lds
    buffer_load_dwordx4 v24, s[12:15], s47 offen offset:2112 lds
    buffer_load_dwordx4 v25, s[12:15], s47 offen offset:3168 lds
    s_mov_b32 m0, 0x1ef00
    s_add_u32 s47, s62, 0x10000
    buffer_load_dwordx4 v22, s[12:15], s47 offen offset:0 lds
    buffer_load_dwordx4 v23, s[12:15], s47 offen offset:1056 lds
    buffer_load_dwordx4 v24, s[12:15], s47 offen offset:2112 lds
    buffer_load_dwordx4 v25, s[12:15], s47 offen offset:3168 lds
    s_add_u32 s62, s78, 2
    s_and_b32 s62, s62, 7
    s_lshl_b32 s62, s62, 7
    s_mov_b32 m0, 0xd680
    s_add_u32 s47, s62, 0
    buffer_load_dwordx4 v26, s[8:11], s47 offen offset:0 lds
    buffer_load_dwordx4 v27, s[8:11], s47 offen offset:1056 lds
    buffer_load_dwordx4 v28, s[8:11], s47 offen offset:2112 lds
    buffer_load_dwordx4 v29, s[8:11], s47 offen offset:3168 lds
    s_mov_b32 m0, 0xe700
    s_add_u32 s47, s62, 0x8000
    buffer_load_dwordx4 v26, s[8:11], s47 offen offset:0 lds
    buffer_load_dwordx4 v27, s[8:11], s47 offen offset:1056 lds
    buffer_load_dwordx4 v28, s[8:11], s47 offen offset:2112 lds
    buffer_load_dwordx4 v29, s[8:11], s47 offen offset:3168 lds
    s_mov_b32 m0, 0xf780
    s_add_u32 s47, s62, 0x10000
    buffer_load_dwordx4 v26, s[8:11], s47 offen offset:0 lds
    buffer_load_dwordx4 v27, s[8:11], s47 offen offset:1056 lds
    buffer_load_dwordx4 v28, s[8:11], s47 offen offset:2112 lds
    buffer_load_dwordx4 v29, s[8:11], s47 offen offset:3168 lds
    s_mov_b32 m0, 0x10800
    s_add_u32 s47, s62, 0x18000
    buffer_load_dwordx4 v26, s[8:11], s47 offen offset:0 lds
    buffer_load_dwordx4 v27, s[8:11], s47 offen offset:1056 lds
    buffer_load_dwordx4 v28, s[8:11], s47 offen offset:2112 lds
    buffer_load_dwordx4 v29, s[8:11], s47 offen offset:3168 lds
    s_mov_b32 m0, 0x11880
    s_add_u32 s47, s62, 0x20000
    buffer_load_dwordx4 v26, s[8:11], s47 offen offset:0 lds
    buffer_load_dwordx4 v27, s[8:11], s47 offen offset:1056 lds
    buffer_load_dwordx4 v28, s[8:11], s47 offen offset:2112 lds
    buffer_load_dwordx4 v29, s[8:11], s47 offen offset:3168 lds
    s_mov_b32 m0, 0x12900
    s_add_u32 s47, s62, 0x28000
    buffer_load_dwordx4 v26, s[8:11], s47 offen offset:0 lds
    buffer_load_dwordx4 v27, s[8:11], s47 offen offset:1056 lds
    buffer_load_dwordx4 v28, s[8:11], s47 offen offset:2112 lds
    buffer_load_dwordx4 v29, s[8:11], s47 offen offset:3168 lds
    s_mov_b32 m0, 0x13980
    s_nop 0
    buffer_load_dwordx4 v20, s[8:11], s62 offen offset:0 lds
    buffer_load_dwordx4 v21, s[8:11], s62 offen offset:1056 lds
    s_waitcnt vmcnt(0)
    v_mov_b32 v17, 3
    ds_write_b32 v16, v17
L_k_poll_hw4:
    ds_read_b128 v[8:11], v0 offset:16
    s_waitcnt lgkmcnt(0)
    v_min3_u32 v8, v8, v9, v10
    v_min_u32 v8, v8, v11
    v_cmp_gt_u32 vcc, 4, v8
    s_cbranch_vccz L_k_pok_hw4
    s_sleep 1
    s_sub_u32 s80, s80, 1
    s_cbranch_scc0 L_k_poll_hw4
    s_endpgm
L_k_pok_hw4:
    s_add_u32 s62, s78, 3
    s_and_b32 s62, s62, 7
    s_lshl_b32 s62, s62, 19
    s_add_u32 s62, s62, 0x40000
    s_mov_b32 m0, 0x24180
    s_add_u32 s47, s62, 0
    buffer_load_dwordx4 v22, s[12:15], s47 offen offset:0 lds
    buffer_load_dwordx4 v23, s[12:15], s47 offen offset:1056 lds
    buffer_load_dwordx4 v24, s[12:15], s47 offen offset:2112 lds
    buffer_load_dwordx4 v25, s[12:15], s47 offen offset:3168 lds
    s_mov_b32 m0, 0x25200
    s_add_u32 s47, s62, 0x10000
    buffer_load_dwordx4 v22, s[12:15], s47 offen offset:0 lds
    buffer_load_dwordx4 v23, s[12:15], s47 offen offset:1056 lds
    buffer_load_dwordx4 v24, s[12:15], s47 offen offset:2112 lds
    buffer_load_dwordx4 v25, s[12:15], s47 offen offset:3168 lds
    s_add_u32 s62, s78, 4
    s_and_b32 s62, s62, 7
    s_lshl_b32 s62, s62, 19
    s_mov_b32 m0, 0x15a80
    s_add_u32 s47, s62, 0
    buffer_load_dwordx4 v22, s[12:15], s47 offen offset:0 lds
    buffer_load_dwordx4 v23, s[12:15], s47 offen offset:1056 lds
    buffer_load_dwordx4 v24, s[12:15], s47 offen offset:2112 lds
    buffer_load_dwordx4 v25, s[12:15], s47 offen offset:3168 lds
    s_mov_b32 m0, 0x16b00
    s_add_u32 s47, s62, 0x10000
    buffer_load_dwordx4 v22, s[12:15], s47 offen offset:0 lds
    buffer_load_dwordx4 v23, s[12:15], s47 offen offset:1056 lds
    buffer_load_dwordx4 v24, s[12:15], s47 offen offset:2112 lds
    buffer_load_dwordx4 v25, s[12:15], s47 offen offset:3168 lds
L_k_poll_hx4:
    ds_read_b128 v[8:11], v0 offset:16
    s_waitcnt lgkmcnt(0)
    v_min3_u32 v8, v8, v9, v10
    v_min_u32 v8, v8, v11
    v_cmp_gt_u32 vcc, 5, v8
    s_cbranch_vccz L_k_pok_hx4
    s_sleep 1
    s_sub_u32 s80, s80, 1
    s_cbranch_scc0 L_k_poll_hx4
    s_endpgm
L_k_pok_hx4:
    s_add_u32 s62, s78, 4
    s_and_b32 s62, s62, 7
    s_lshl_b32 s62, s62, 7
    s_mov_b32 m0, 0x6b40
    s_add_u32 s47, s62, 0
    buffer_load_dwordx4 v26, s[8:11], s47 offen offset:0 lds
    buffer_load_dwordx4 v27, s[8:11], s47 offen offset:1056 lds
    buffer_load_dwordx4 v28, s[8:11], s47 offen offset:2112 lds
    buffer_load_dwordx4 v29, s[8:11], s47 offen offset:3168 lds
    s_mov_b32 m0, 0x7bc0
    s_add_u32 s47, s62, 0x8000
    buffer_load_dwordx4 v26, s[8:11], s47 offen offset:0 lds
    buffer_load_dwordx4 v27, s[8:11], s47 offen offset:1056 lds
    buffer_load_dwordx4 v28, s[8:11], s47 offen offset:2112 lds
    buffer_load_dwordx4 v29, s[8:11], s47 offen offset:3168 lds
    s_mov_b32 m0, 0x8c40
    s_add_u32 s47, s62, 0x10000
    buffer_load_dwordx4 v26, s[8:11], s47 offen offset:0 lds
    buffer_load_dwordx4 v27, s[8:11], s47 offen offset:1056 lds
    buffer_load_dwordx4 v28, s[8:11], s47 offen offset:2112 lds
    buffer_load_dwordx4 v29, s[8:11], s47 offen offset:3168 lds
    s_mov_b32 m0, 0x9cc0
    s_add_u32 s47, s62, 0x18000
    buffer_load_dwordx4 v26, s[8:11], s47 offen offset:0 lds
    buffer_load_dwordx4 v27, s[8:11], s47 offen offset:1056 lds
    buffer_load_dwordx4 v28, s[8:11], s47 offen offset:2112 lds
    buffer_load_dwordx4 v29, s[8:11], s47 offen offset:3168 lds
    s_mov_b32 m0, 0xad40
    s_add_u32 s47, s62, 0x20000
    buffer_load_dwordx4 v26, s[8:11], s47 offen offset:0 lds
    buffer_load_dwordx4 v27, s[8:11], s47 offen offset:1056 lds
    buffer_load_dwordx4 v28, s[8:11], s47 offen offset:2112 lds
    buffer_load_dwordx4 v29, s[8:11], s47 offen offset:3168 lds
    s_mov_b32 m0, 0xbdc0
    s_add_u32 s47, s62, 0x28000
    buffer_load_dwordx4 v26, s[8:11], s47 offen offset:0 lds
    buffer_load_dwordx4 v27, s[8:11], s47 offen offset:1056 lds
    buffer_load_dwordx4 v28, s[8:11], s47 offen offset:2112 lds
    buffer_load_dwordx4 v29, s[8:11], s47 offen offset:3168 lds
    s_mov_b32 m0, 0xce40
    s_nop 0
    buffer_load_dwordx4 v20, s[8:11], s62 offen offset:0 lds
    buffer_load_dwordx4 v21, s[8:11], s62 offen offset:1056 lds
    s_waitcnt vmcnt(0)
    v_mov_b32 v17, 5
    ds_write_b32 v16, v17
L_k_poll_hw6:
    ds_read_b128 v[8:11], v0 offset:16
    s_waitcnt lgkmcnt(0)
    v_min3_u32 v8, v8, v9, v10
    v_min_u32 v8, v8, v11
    v_cmp_gt_u32 vcc, 12, v8
    s_cbranch_vccz L_k_pok_hw6
    s_sleep 1
    s_sub_u32 s80, s80, 1
    s_cbranch_scc0 L_k_poll_hw6
    s_endpgm
L_k_pok_hw6:
    s_add_u32 s62, s78, 5
    s_and_b32 s62, s62, 7
    s_lshl_b32 s62, s62, 19
    s_add_u32 s62, s62, 0x40000
    s_mov_b32 m0, 0x1bd80
    s_add_u32 s47, s62, 0
    buffer_load_dwordx4 v22, s[12:15], s47 offen offset:0 lds
    buffer_load_dwordx4 v23, s[12:15], s47 offen offset:1056 lds
    buffer_load_dwordx4 v24, s[12:15], s47 offen offset:2112 lds
    buffer_load_dwordx4 v25, s[12:15], s47 offen offset:3168 lds
    s_mov_b32 m0, 0x1ce00
    s_add_u32 s47, s62, 0x10000
    buffer_load_dwordx4 v22, s[12:15], s47 offen offset:0 lds
    buffer_load_dwordx4 v23, s[12:15], s47 offen offset:1056 lds
    buffer_load_dwordx4 v24, s[12:15], s47 offen offset:2112 lds
    buffer_load_dwordx4 v25, s[12:15], s47 offen offset:3168 lds
    s_add_u32 s62, s78, 6
    s_and_b32 s62, s62, 7
    s_lshl_b32 s62, s62, 19
    s_mov_b32 m0, 0x1de80
    s_add_u32 s47, s62, 0
    buffer_load_dwordx4 v22, s[12:15], s47 offen offset:0 lds
    buffer_load_dwordx4 v23, s[12:15], s47 offen offset:1056 lds
    buffer_load_dwordx4 v24, s[12:15], s47 offen offset:2112 lds
    buffer_load_dwordx4 v25, s[12:15], s47 offen offset:3168 lds
    s_mov_b32 m0, 0x1ef00
    s_add_u32 s47, s62, 0x10000
    buffer_load_dwordx4 v22, s[12:15], s47 offen offset:0 lds
    buffer_load_dwordx4 v23, s[12:15], s47 offen offset:1056 lds
    buffer_load_dwordx4 v24, s[12:15], s47 offen offset:2112 lds
    buffer_load_dwordx4 v25, s[12:15], s47 offen offset:3168 lds
L_k_poll_hx6:
    ds_read_b128 v[8:11], v0 offset:16
    s_waitcnt lgkmcnt(0)
    v_min3_u32 v8, v8, v9, v10
    v_min_u32 v8, v8, v11
    v_cmp_gt_u32 vcc, 13, v8
    s_cbranch_vccz L_k_pok_hx6
    s_sleep 1
    s_sub_u32 s80, s80, 1
    s_cbranch_scc0 L_k_poll_hx6
    s_endpgm
L_k_pok_hx6:
    s_add_u32 s62, s78, 6
    s_and_b32 s62, s62, 7
    s_lshl_b32 s62, s62, 7
    s_mov_b32 m0, 0
    s_add_u32 s47, s62, 0
    buffer_load_dwordx4 v26, s[8:11], s47 offen offset:0 lds
    buffer_load_dwordx4 v27, s[8:11], s47 offen offset:1056 lds
    buffer_load_dwordx4 v28, s[8:11], s47 offen offset:2112 lds
    buffer_load_dwordx4 v29, s[8:11], s47 offen offset:3168 lds
    s_mov_b32 m0, 0x1080
    s_add_u32 s47, s62, 0x8000
    buffer_load_dwordx4 v26, s[8:11], s47 offen offset:0 lds
    buffer_load_dwordx4 v27, s[8:11], s47 offen offset:1056 lds
    buffer_load_dwordx4 v28, s[8:11], s47 offen offset:2112 lds
    buffer_load_dwordx4 v29, s[8:11], s47 offen offset:3168 lds
    s_mov_b32 m0, 0x2100
    s_add_u32 s47, s62, 0x10000
    buffer_load_dwordx4 v26, s[8:11], s47 offen offset:0 lds
    buffer_load_dwordx4 v27, s[8:11], s47 offen offset:1056 lds
    buffer_load_dwordx4 v28, s[8:11], s47 offen offset:2112 lds
    buffer_load_dwordx4 v29, s[8:11], s47 offen offset:3168 lds
    s_mov_b32 m0, 0x3180
    s_add_u32 s47, s62, 0x18000
    buffer_load_dwordx4 v26, s[8:11], s47 offen offset:0 lds
    buffer_load_dwordx4 v27, s[8:11], s47 offen offset:1056 lds
    buffer_load_dwordx4 v28, s[8:11], s47 offen offset:2112 lds
    buffer_load_dwordx4 v29, s[8:11], s47 offen offset:3168 lds
    s_mov_b32 m0, 0x4200
    s_add_u32 s47, s62, 0x20000
    buffer_load_dwordx4 v26, s[8:11], s47 offen offset:0 lds
    buffer_load_dwordx4 v27, s[8:11], s47 offen offset:1056 lds
    buffer_load_dwordx4 v28, s[8:11], s47 offen offset:2112 lds
    buffer_load_dwordx4 v29, s[8:11], s47 offen offset:3168 lds
    s_mov_b32 m0, 0x5280
    s_add_u32 s47, s62, 0x28000
    buffer_load_dwordx4 v26, s[8:11], s47 offen offset:0 lds
    buffer_load_dwordx4 v27, s[8:11], s47 offen offset:1056 lds
    buffer_load_dwordx4 v28, s[8:11], s47 offen offset:2112 lds
    buffer_load_dwordx4 v29, s[8:11], s47 offen offset:3168 lds
    s_mov_b32 m0, 0x6300
    s_nop 0
    buffer_load_dwordx4 v20, s[8:11], s62 offen offset:0 lds
    buffer_load_dwordx4 v21, s[8:11], s62 offen offset:1056 lds
    s_waitcnt vmcnt(0)
    v_mov_b32 v17, 7
    ds_write_b32 v16, v17
L_k_poll_hw8:
    ds_read_b128 v[8:11], v0 offset:16
    s_waitcnt lgkmcnt(0)
    v_min3_u32 v8, v8, v9, v10
    v_min_u32 v8, v8, v11
    v_cmp_gt_u32 vcc, 20, v8
    s_cbranch_vccz L_k_pok_hw8
    s_sleep 1
    s_sub_u32 s80, s80, 1
    s_cbranch_scc0 L_k_poll_hw8
    s_endpgm
L_k_pok_hw8:
    s_add_u32 s62, s78, 7
    s_and_b32 s62, s62, 7
    s_lshl_b32 s62, s62, 19
    s_add_u32 s62, s62, 0x40000
    s_mov_b32 m0, 0x24180
    s_add_u32 s47, s62, 0
    buffer_load_dwordx4 v22, s[12:15], s47 offen offset:0 lds
    buffer_load_dwordx4 v23, s[12:15], s47 offen offset:1056 lds
    buffer_load_dwordx4 v24, s[12:15], s47 offen offset:2112 lds
    buffer_load_dwordx4 v25, s[12:15], s47 offen offset:3168 lds
    s_mov_b32 m0, 0x25200
    s_add_u32 s47, s62, 0x10000
    buffer_load_dwordx4 v22, s[12:15], s47 offen offset:0 lds
    buffer_load_dwordx4 v23, s[12:15], s47 offen offset:1056 lds
    buffer_load_dwordx4 v24, s[12:15], s47 offen offset:2112 lds
    buffer_load_dwordx4 v25, s[12:15], s47 offen offset:3168 lds
    s_waitcnt vmcnt(0)
    v_mov_b32 v17, 9
    ds_write_b32 v16, v17
    s_branch L_k_f2
L_k_f1:
    s_barrier
    s_add_u32 s62, s78, 0
    s_and_b32 s62, s62, 7
    s_lshl_b32 s62, s62, 19
    s_add_u32 s62, s62, 0x40000
    s_mov_b32 m0, 0x17b80
    s_add_u32 s47, s62, 0
    buffer_load_dwordx4 v22, s[12:15], s47 offen offset:0 lds
    buffer_load_dwordx4 v23, s[12:15], s47 offen offset:1056 lds
    buffer_load_dwordx4 v24, s[12:15], s47 offen offset:2112 lds
    buffer_load_dwordx4 v25, s[12:15], s47 offen offset:3168 lds
    s_mov_b32 m0, 0x18c00
    s_add_u32 s47, s62, 0x10000
    buffer_load_dwordx4 v22, s[12:15], s47 offen offset:0 lds
    buffer_load_dwordx4 v23, s[12:15], s47 offen offset:1056 lds
    buffer_load_dwordx4 v24, s[12:15], s47 offen offset:2112 lds
    buffer_load_dwordx4 v25, s[12:15], s47 offen offset:3168 lds
    s_add_u32 s62, s78, 1
    s_and_b32 s62, s62, 7
    s_lshl_b32 s62, s62, 19
    s_mov_b32 m0, 0x19c80
    s_add_u32 s47, s62, 0
    buffer_load_dwordx4 v22, s[12:15], s47 offen offset:0 lds
    buffer_load_dwordx4 v23, s[12:15], s47 offen offset:1056 lds
    buffer_load_dwordx4 v24, s[12:15], s47 offen offset:2112 lds
    buffer_load_dwordx4 v25, s[12:15], s47 offen offset:3168 lds
    s_mov_b32 m0, 0x1ad00
    s_add_u32 s47, s62, 0x10000
    buffer_load_dwordx4 v22, s[12:15], s47 offen offset:0 lds
    buffer_load_dwordx4 v23, s[12:15], s47 offen offset:1056 lds
    buffer_load_dwordx4 v24, s[12:15], s47 offen offset:2112 lds
    buffer_load_dwordx4 v25, s[12:15], s47 offen offset:3168 lds
    s_add_u32 s62, s78, 1
    s_and_b32 s62, s62, 7
    s_lshl_b32 s62, s62, 7
    s_mov_b32 m0, 0x6b40
    s_add_u32 s47, s62, 0
    buffer_load_dwordx4 v26, s[8:11], s47 offen offset:0 lds
    buffer_load_dwordx4 v27, s[8:11], s47 offen offset:1056 lds
    buffer_load_dwordx4 v28, s[8:11], s47 offen offset:2112 lds
    buffer_load_dwordx4 v29, s[8:11], s47 offen offset:3168 lds
    s_mov_b32 m0, 0x7bc0
    s_add_u32 s47, s62, 0x8000
    buffer_load_dwordx4 v26, s[8:11], s47 offen offset:0 lds
    buffer_load_dwordx4 v27, s[8:11], s47 offen offset:1056 lds
    buffer_load_dwordx4 v28, s[8:11], s47 offen offset:2112 lds
    buffer_load_dwordx4 v29, s[8:11], s47 offen offset:3168 lds
    s_mov_b32 m0, 0x8c40
    s_add_u32 s47, s62, 0x10000
    buffer_load_dwordx4 v26, s[8:11], s47 offen offset:0 lds
    buffer_load_dwordx4 v27, s[8:11], s47 offen offset:1056 lds
    buffer_load_dwordx4 v28, s[8:11], s47 offen offset:2112 lds
    buffer_load_dwordx4 v29, s[8:11], s47 offen offset:3168 lds
    s_mov_b32 m0, 0x9cc0
    s_add_u32 s47, s62, 0x18000
    buffer_load_dwordx4 v26, s[8:11], s47 offen offset:0 lds
    buffer_load_dwordx4 v27, s[8:11], s47 offen offset:1056 lds
    buffer_load_dwordx4 v28, s[8:11], s47 offen offset:2112 lds
    buffer_load_dwordx4 v29, s[8:11], s47 offen offset:3168 lds
    s_mov_b32 m0, 0xad40
    s_add_u32 s47, s62, 0x20000
    buffer_load_dwordx4 v26, s[8:11], s47 offen offset:0 lds
    buffer_load_dwordx4 v27, s[8:11], s47 offen offset:1056 lds
    buffer_load_dwordx4 v28, s[8:11], s47 offen offset:2112 lds
    buffer_load_dwordx4 v29, s[8:11], s47 offen offset:3168 lds
    s_mov_b32 m0, 0xbdc0
    s_add_u32 s47, s62, 0x28000
    buffer_load_dwordx4 v26, s[8:11], s47 offen offset:0 lds
    buffer_load_dwordx4 v27, s[8:11], s47 offen offset:1056 lds
    buffer_load_dwordx4 v28, s[8:11], s47 offen offset:2112 lds
    buffer_load_dwordx4 v29, s[8:11], s47 offen offset:3168 lds
    s_mov_b32 m0, 0xce40
    s_nop 0
    buffer_load_dwordx4 v20, s[8:11], s62 offen offset:0 lds
    buffer_load_dwordx4 v21, s[8:11], s62 offen offset:1056 lds
    s_waitcnt vmcnt(0)
    v_mov_b32 v17, 2
    ds_write_b32 v16, v17
    s_add_u32 s62, s78, 2
    s_and_b32 s62, s62, 7
    s_lshl_b32 s62, s62, 19
    s_add_u32 s62, s62, 0x40000
    s_mov_b32 m0, 0x1ff80
    s_add_u32 s47, s62, 0
    buffer_load_dwordx4 v22, s[12:15], s47 offen offset:0 lds
    buffer_load_dwordx4 v23, s[12:15], s47 offen offset:1056 lds
    buffer_load_dwordx4 v24, s[12:15], s47 offen offset:2112 lds
    buffer_load_dwordx4 v25, s[12:15], s47 offen offset:3168 lds
    s_mov_b32 m0, 0x21000
    s_add_u32 s47, s62, 0x10000
    buffer_load_dwordx4 v22, s[12:15], s47 offen offset:0 lds
    buffer_load_dwordx4 v23, s[12:15], s47 offen offset:1056 lds
    buffer_load_dwordx4 v24, s[12:15], s47 offen offset:2112 lds
    buffer_load_dwordx4 v25, s[12:15], s47 offen offset:3168 lds
    s_add_u32 s62, s78, 3
    s_and_b32 s62, s62, 7
    s_lshl_b32 s62, s62, 19
    s_mov_b32 m0, 0x22080
    s_add_u32 s47, s62, 0
    buffer_load_dwordx4 v22, s[12:15], s47 offen offset:0 lds
    buffer_load_dwordx4 v23, s[12:15], s47 offen offset:1056 lds
    buffer_load_dwordx4 v24, s[12:15], s47 offen offset:2112 lds
    buffer_load_dwordx4 v25, s[12:15], s47 offen offset:3168 lds
    s_mov_b32 m0, 0x23100
    s_add_u32 s47, s62, 0x10000
    buffer_load_dwordx4 v22, s[12:15], s47 offen offset:0 lds
    buffer_load_dwordx4 v23, s[12:15], s47 offen offset:1056 lds
    buffer_load_dwordx4 v24, s[12:15], s47 offen offset:2112 lds
    buffer_load_dwordx4 v25, s[12:15], s47 offen offset:3168 lds
L_k_poll_hx3:
    ds_read_b128 v[8:11], v0 offset:16
    s_waitcnt lgkmcnt(0)
    v_min3_u32 v8, v8, v9, v10
    v_min_u32 v8, v8, v11
    v_cmp_gt_u32 vcc, 1, v8
    s_cbranch_vccz L_k_pok_hx3
    s_sleep 1
    s_sub_u32 s80, s80, 1
    s_cbranch_scc0 L_k_poll_hx3
    s_endpgm
L_k_pok_hx3:
    s_add_u32 s62, s78, 3
    s_and_b32 s62, s62, 7
    s_lshl_b32 s62, s62, 7
    s_mov_b32 m0, 0
    s_add_u32 s47, s62, 0
    buffer_load_dwordx4 v26, s[8:11], s47 offen offset:0 lds
    buffer_load_dwordx4 v27, s[8:11], s47 offen offset:1056 lds
    buffer_load_dwordx4 v28, s[8:11], s47 offen offset:2112 lds
    buffer_load_dwordx4 v29, s[8:11], s47 offen offset:3168 lds
    s_mov_b32 m0, 0x1080
    s_add_u32 s47, s62, 0x8000
    buffer_load_dwordx4 v26, s[8:11], s47 offen offset:0 lds
    buffer_load_dwordx4 v27, s[8:11], s47 offen offset:1056 lds
    buffer_load_dwordx4 v28, s[8:11], s47 offen offset:2112 lds
    buffer_load_dwordx4 v29, s[8:11], s47 offen offset:3168 lds
    s_mov_b32 m0, 0x2100
    s_add_u32 s47, s62, 0x10000
    buffer_load_dwordx4 v26, s[8:11], s47 offen offset:0 lds
    buffer_load_dwordx4 v27, s[8:11], s47 offen offset:1056 lds
    buffer_load_dwordx4 v28, s[8:11], s47 offen offset:2112 lds
    buffer_load_dwordx4 v29, s[8:11], s47 offen offset:3168 lds
    s_mov_b32 m0, 0x3180
    s_add_u32 s47, s62, 0x18000
    buffer_load_dwordx4 v26, s[8:11], s47 offen offset:0 lds
    buffer_load_dwordx4 v27, s[8:11], s47 offen offset:1056 lds
    buffer_load_dwordx4 v28, s[8:11], s47 offen offset:2112 lds
    buffer_load_dwordx4 v29, s[8:11], s47 offen offset:3168 lds
    s_mov_b32 m0, 0x4200
    s_add_u32 s47, s62, 0x20000
    buffer_load_dwordx4 v26, s[8:11], s47 offen offset:0 lds
    buffer_load_dwordx4 v27, s[8:11], s47 offen offset:1056 lds
    buffer_load_dwordx4 v28, s[8:11], s47 offen offset:2112 lds
    buffer_load_dwordx4 v29, s[8:11], s47 offen offset:3168 lds
    s_mov_b32 m0, 0x5280
    s_add_u32 s47, s62, 0x28000
    buffer_load_dwordx4 v26, s[8:11], s47 offen offset:0 lds
    buffer_load_dwordx4 v27, s[8:11], s47 offen offset:1056 lds
    buffer_load_dwordx4 v28, s[8:11], s47 offen offset:2112 lds
    buffer_load_dwordx4 v29, s[8:11], s47 offen offset:3168 lds
    s_mov_b32 m0, 0x6300
    s_nop 0
    buffer_load_dwordx4 v20, s[8:11], s62 offen offset:0 lds
    buffer_load_dwordx4 v21, s[8:11], s62 offen offset:1056 lds
    s_waitcnt vmcnt(0)
    v_mov_b32 v17, 4
    ds_write_b32 v16, v17
L_k_poll_hw5:
    ds_read_b128 v[8:11], v0 offset:16
    s_waitcnt lgkmcnt(0)
    v_min3_u32 v8, v8, v9, v10
    v_min_u32 v8, v8, v11
    v_cmp_gt_u32 vcc, 8, v8
    s_cbranch_vccz L_k_pok_hw5
    s_sleep 1
    s_sub_u32 s80, s80, 1
    s_cbranch_scc0 L_k_poll_hw5
    s_endpgm
L_k_pok_hw5:
    s_add_u32 s62, s78, 4
    s_and_b32 s62, s62, 7
    s_lshl_b32 s62, s62, 19
    s_add_u32 s62, s62, 0x40000
    s_mov_b32 m0, 0x17b80
    s_add_u32 s47, s62, 0
    buffer_load_dwordx4 v22, s[12:15], s47 offen offset:0 lds
    buffer_load_dwordx4 v23, s[12:15], s47 offen offset:1056 lds
    buffer_load_dwordx4 v24, s[12:15], s47 offen offset:2112 lds
    buffer_load_dwordx4 v25, s[12:15], s47 offen offset:3168 lds
    s_mov_b32 m0, 0x18c00
    s_add_u32 s47, s62, 0x10000
    buffer_load_dwordx4 v22, s[12:15], s47 offen offset:0 lds
    buffer_load_dwordx4 v23, s[12:15], s47 offen offset:1056 lds
    buffer_load_dwordx4 v24, s[12:15], s47 offen offset:2112 lds
    buffer_load_dwordx4 v25, s[12:15], s47 offen offset:3168 lds
    s_add_u32 s62, s78, 5
    s_and_b32 s62, s62, 7
    s_lshl_b32 s62, s62, 19
    s_mov_b32 m0, 0x19c80
    s_add_u32 s47, s62, 0
    buffer_load_dwordx4 v22, s[12:15], s47 offen offset:0 lds
    buffer_load_dwordx4 v23, s[12:15], s47 offen offset:1056 lds
    buffer_load_dwordx4 v24, s[12:15], s47 offen offset:2112 lds
    buffer_load_dwordx4 v25, s[12:15], s47 offen offset:3168 lds
    s_mov_b32 m0, 0x1ad00
    s_add_u32 s47, s62, 0x10000
    buffer_load_dwordx4 v22, s[12:15], s47 offen offset:0 lds
    buffer_load_dwordx4 v23, s[12:15], s47 offen offset:1056 lds
    buffer_load_dwordx4 v24, s[12:15], s47 offen offset:2112 lds
    buffer_load_dwordx4 v25, s[12:15], s47 offen offset:3168 lds
L_k_poll_hx5:
    ds_read_b128 v[8:11], v0 offset:16
    s_waitcnt lgkmcnt(0)
    v_min3_u32 v8, v8, v9, v10
    v_min_u32 v8, v8, v11
    v_cmp_gt_u32 vcc, 9, v8
    s_cbranch_vccz L_k_pok_hx5
    s_sleep 1
    s_sub_u32 s80, s80, 1
    s_cbranch_scc0 L_k_poll_hx5
    s_endpgm
L_k_pok_hx5:
    s_add_u32 s62, s78, 5
    s_and_b32 s62, s62, 7
    s_lshl_b32 s62, s62, 7
    s_mov_b32 m0, 0xd680
    s_add_u32 s47, s62, 0
    buffer_load_dwordx4 v26, s[8:11], s47 offen offset:0 lds
    buffer_load_dwordx4 v27, s[8:11], s47 offen offset:1056 lds
    buffer_load_dwordx4 v28, s[8:11], s47 offen offset:2112 lds
    buffer_load_dwordx4 v29, s[8:11], s47 offen offset:3168 lds
    s_mov_b32 m0, 0xe700
    s_add_u32 s47, s62, 0x8000
    buffer_load_dwordx4 v26, s[8:11], s47 offen offset:0 lds
    buffer_load_dwordx4 v27, s[8:11], s47 offen offset:1056 lds
    buffer_load_dwordx4 v28, s[8:11], s47 offen offset:2112 lds
    buffer_load_dwordx4 v29, s[8:11], s47 offen offset:3168 lds
    s_mov_b32 m0, 0xf780
    s_add_u32 s47, s62, 0x10000
    buffer_load_dwordx4 v26, s[8:11], s47 offen offset:0 lds
    buffer_load_dwordx4 v27, s[8:11], s47 offen offset:1056 lds
    buffer_load_dwordx4 v28, s[8:11], s47 offen offset:2112 lds
    buffer_load_dwordx4 v29, s[8:11], s47 offen offset:3168 lds
    s_mov_b32 m0, 0x10800
    s_add_u32 s47, s62, 0x18000
    buffer_load_dwordx4 v26, s[8:11], s47 offen offset:0 lds
    buffer_load_dwordx4 v27, s[8:11], s47 offen offset:1056 lds
    buffer_load_dwordx4 v28, s[8:11], s47 offen offset:2112 lds
    buffer_load_dwordx4 v29, s[8:11], s47 offen offset:3168 lds
    s_mov_b32 m0, 0x11880
    s_add_u32 s47, s62, 0x20000
    buffer_load_dwordx4 v26, s[8:11], s47 offen offset:0 lds
    buffer_load_dwordx4 v27, s[8:11], s47 offen offset:1056 lds
    buffer_load_dwordx4 v28, s[8:11], s47 offen offset:2112 lds
    buffer_load_dwordx4 v29, s[8:11], s47 offen offset:3168 lds
    s_mov_b32 m0, 0x12900
    s_add_u32 s47, s62, 0x28000
    buffer_load_dwordx4 v26, s[8:11], s47 offen offset:0 lds
    buffer_load_dwordx4 v27, s[8:11], s47 offen offset:1056 lds
    buffer_load_dwordx4 v28, s[8:11], s47 offen offset:2112 lds
    buffer_load_dwordx4 v29, s[8:11], s47 offen offset:3168 lds
    s_mov_b32 m0, 0x13980
    s_nop 0
    buffer_load_dwordx4 v20, s[8:11], s62 offen offset:0 lds
    buffer_load_dwordx4 v21, s[8:11], s62 offen offset:1056 lds
    s_waitcnt vmcnt(0)
    v_mov_b32 v17, 6
    ds_write_b32 v16, v17
L_k_poll_hw7:
    ds_read_b128 v[8:11], v0 offset:16
    s_waitcnt lgkmcnt(0)
    v_min3_u32 v8, v8, v9, v10
    v_min_u32 v8, v8, v11
    v_cmp_gt_u32 vcc, 16, v8
    s_cbranch_vccz L_k_pok_hw7
    s_sleep 1
    s_sub_u32 s80, s80, 1
    s_cbranch_scc0 L_k_poll_hw7
    s_endpgm
L_k_pok_hw7:
    s_add_u32 s62, s78, 6
    s_and_b32 s62, s62, 7
    s_lshl_b32 s62, s62, 19
    s_add_u32 s62, s62, 0x40000
    s_mov_b32 m0, 0x1ff80
    s_add_u32 s47, s62, 0
    buffer_load_dwordx4 v22, s[12:15], s47 offen offset:0 lds
    buffer_load_dwordx4 v23, s[12:15], s47 offen offset:1056 lds
    buffer_load_dwordx4 v24, s[12:15], s47 offen offset:2112 lds
    buffer_load_dwordx4 v25, s[12:15], s47 offen offset:3168 lds
    s_mov_b32 m0, 0x21000
    s_add_u32 s47, s62, 0x10000
    buffer_load_dwordx4 v22, s[12:15], s47 offen offset:0 lds
    buffer_load_dwordx4 v23, s[12:15], s47 offen offset:1056 lds
    buffer_load_dwordx4 v24, s[12:15], s47 offen offset:2112 lds
    buffer_load_dwordx4 v25, s[12:15], s47 offen offset:3168 lds
    s_add_u32 s62, s78, 7
    s_and_b32 s62, s62, 7
    s_lshl_b32 s62, s62, 19
    s_mov_b32 m0, 0x22080
    s_add_u32 s47, s62, 0
    buffer_load_dwordx4 v22, s[12:15], s47 offen offset:0 lds
    buffer_load_dwordx4 v23, s[12:15], s47 offen offset:1056 lds
    buffer_load_dwordx4 v24, s[12:15], s47 offen offset:2112 lds
    buffer_load_dwordx4 v25, s[12:15], s47 offen offset:3168 lds
    s_mov_b32 m0, 0x23100
    s_add_u32 s47, s62, 0x10000
    buffer_load_dwordx4 v22, s[12:15], s47 offen offset:0 lds
    buffer_load_dwordx4 v23, s[12:15], s47 offen offset:1056 lds
    buffer_load_dwordx4 v24, s[12:15], s47 offen offset:2112 lds
    buffer_load_dwordx4 v25, s[12:15], s47 offen offset:3168 lds
L_k_poll_hx7:
    ds_read_b128 v[8:11], v0 offset:16
    s_waitcnt lgkmcnt(0)
    v_min3_u32 v8, v8, v9, v10
    v_min_u32 v8, v8, v11
    v_cmp_gt_u32 vcc, 17, v8
    s_cbranch_vccz L_k_pok_hx7
    s_sleep 1
    s_sub_u32 s80, s80, 1
    s_cbranch_scc0 L_k_poll_hx7
    s_endpgm
L_k_pok_hx7:
    s_add_u32 s62, s78, 7
    s_and_b32 s62, s62, 7
    s_lshl_b32 s62, s62, 7
    s_mov_b32 m0, 0x6b40
    s_add_u32 s47, s62, 0
    buffer_load_dwordx4 v26, s[8:11], s47 offen offset:0 lds
    buffer_load_dwordx4 v27, s[8:11], s47 offen offset:1056 lds
    buffer_load_dwordx4 v28, s[8:11], s47 offen offset:2112 lds
    buffer_load_dwordx4 v29, s[8:11], s47 offen offset:3168 lds
    s_mov_b32 m0, 0x7bc0
    s_add_u32 s47, s62, 0x8000
    buffer_load_dwordx4 v26, s[8:11], s47 offen offset:0 lds
    buffer_load_dwordx4 v27, s[8:11], s47 offen offset:1056 lds
    buffer_load_dwordx4 v28, s[8:11], s47 offen offset:2112 lds
    buffer_load_dwordx4 v29, s[8:11], s47 offen offset:3168 lds
    s_mov_b32 m0, 0x8c40
    s_add_u32 s47, s62, 0x10000
    buffer_load_dwordx4 v26, s[8:11], s47 offen offset:0 lds
    buffer_load_dwordx4 v27, s[8:11], s47 offen offset:1056 lds
    buffer_load_dwordx4 v28, s[8:11], s47 offen offset:2112 lds
    buffer_load_dwordx4 v29, s[8:11], s47 offen offset:3168 lds
    s_mov_b32 m0, 0x9cc0
    s_add_u32 s47, s62, 0x18000
    buffer_load_dwordx4 v26, s[8:11], s47 offen offset:0 lds
    buffer_load_dwordx4 v27, s[8:11], s47 offen offset:1056 lds
    buffer_load_dwordx4 v28, s[8:11], s47 offen offset:2112 lds
    buffer_load_dwordx4 v29, s[8:11], s47 offen offset:3168 lds
    s_mov_b32 m0, 0xad40
    s_add_u32 s47, s62, 0x20000
    buffer_load_dwordx4 v26, s[8:11], s47 offen offset:0 lds
    buffer_load_dwordx4 v27, s[8:11], s47 offen offset:1056 lds
    buffer_load_dwordx4 v28, s[8:11], s47 offen offset:2112 lds
    buffer_load_dwordx4 v29, s[8:11], s47 offen offset:3168 lds
    s_mov_b32 m0, 0xbdc0
    s_add_u32 s47, s62, 0x28000
    buffer_load_dwordx4 v26, s[8:11], s47 offen offset:0 lds
    buffer_load_dwordx4 v27, s[8:11], s47 offen offset:1056 lds
    buffer_load_dwordx4 v28, s[8:11], s47 offen offset:2112 lds
    buffer_load_dwordx4 v29, s[8:11], s47 offen offset:3168 lds
    s_mov_b32 m0, 0xce40
    s_nop 0
    buffer_load_dwordx4 v20, s[8:11], s62 offen offset:0 lds
    buffer_load_dwordx4 v21, s[8:11], s62 offen offset:1056 lds
    v_mov_b32 v17, 1
    ds_write_b32 v0, v17 offset:120
    s_waitcnt vmcnt(0)
    v_mov_b32 v17, 8
    ds_write_b32 v16, v17
L_k_f2:
    s_mul_i32 s47, s45, 0x1a0000
    s_lshl_b32 s48, s82, 15
    s_add_u32 s47, s47, s48
    s_add_u32 s16, s42, s47
    s_addc_u32 s17, s43, 0
    s_sub_u32 s18, 0x1a0000, s48
    s_mov_b32 s19, 0x20000
    s_lshl_b32 s47, s45, 3
    s_add_u32 s47, s47, s81
    s_lshl_b32 s84, s47, 7
    s_mul_i32 s47, s47, 0x34000
    s_add_u32 s47, s47, 0x1000000
    s_add_u32 s20, s42, s47
    s_addc_u32 s21, s43, 0
    s_mov_b32 s22, 0x34000
    s_mov_b32 s23, 0x20000
    s_mul_i32 s47, s45, 0x34000
    s_lshl_b32 s48, s81, 7
    s_add_u32 s47, s47, s48
    s_add_u32 s24, s38, s47
    s_addc_u32 s25, s39, 0
    s_sub_u32 s26, 0x1a0000, s47
    s_mov_b32 s27, 0x20000
    s_add_u32 s72, s42, 0x2000000
    s_addc_u32 s73, s43, 0
    s_mov_b32 s74, 0x10000
    s_mov_b32 s75, 0x20000
    s_lshl_b32 s47, s45, 2
    s_add_u32 s47, s47, s82
    s_add_u32 s47, s47, 64
    s_lshl_b32 s83, s47, 7
    s_add_u32 s68, s40, 0
    s_addc_u32 s69, s41, 0
    s_mov_b32 s70, 0x100
    s_mov_b32 s71, 0x20000
    s_cmp_eq_u32 s76, 0
    s_cbranch_scc0 L_k_nononce
    s_lshl_b32 s47, s45, 5
    v_mov_b32 v5, s47
    s_mov_b64 exec, 1
L_k_nn:
    buffer_load_dword v8, v5, s[68:71], 0 offen sc1
    s_waitcnt vmcnt(0)
    v_cmp_eq_u32 vcc, 0, v8
    s_cbranch_vccz L_k_nnok
    s_sleep 4
    s_sub_u32 s80, s80, 1
    s_cbranch_scc0 L_k_nn
    s_endpgm
L_k_nnok:
    ds_write_b32 v0, v8 offset:116
    s_mov_b64 exec, -1
L_k_nononce:
    v_and_b32 v5, 7, v1
    v_mul_u32_u24 v2, 0x420, v5
    v_bfe_u32 v5, v1, 3, 1
    v_lshl_add_u32 v2, v5, 8, v2
    v_lshrrev_b32 v5, 4, v1
    v_lshl_add_u32 v2, v5, 4, v2
    v_bfe_u32 v5, v1, 2, 3
    v_mul_u32_u24 v3, 0x420, v5
    v_lshrrev_b32 v5, 5, v1
    v_lshl_add_u32 v3, v5, 8, v3
    v_and_b32 v5, 3, v1
    v_lshl_add_u32 v3, v5, 3, v3
    s_mul_i32 s47, s76, 0x2100
    v_add_u32 v2, s47, v2
    s_add_u32 s47, s47, 0x4200
    v_add_u32 v3, s47, v3
    v_mov_b32 v36, 0
    v_mov_b32 v37, 0
    v_mov_b32 v38, 0
    v_mov_b32 v39, 0
    v_mov_b32 v40, 0
    v_mov_b32 v41, 0
    v_mov_b32 v42, 0
    v_mov_b32 v43, 0
    v_mov_b32 v44, 0
    v_mov_b32 v45, 0
    v_mov_b32 v46, 0
    v_mov_b32 v47, 0
    v_mov_b32 v48, 0
    v_mov_b32 v49, 0
    v_mov_b32 v50, 0
    v_mov_b32 v51, 0
    v_mov_b32 v52, 0
    v_mov_b32 v53, 0
    v_mov_b32 v54, 0
    v_mov_b32 v55, 0
    v_mov_b32 v56, 0
    v_mov_b32 v57, 0
    v_mov_b32 v58, 0
    v_mov_b32 v59, 0
    v_mov_b32 v60, 0
    v_mov_b32 v61, 0
    v_mov_b32 v62, 0
    v_mov_b32 v63, 0
    v_mov_b32 v64, 0
    v_mov_b32 v65, 0
    v_mov_b32 v66, 0
    v_mov_b32 v67, 0
    v_mov_b32 v32, 0
    v_mov_b32 v20, 0x7f000000
    v_mov_b32 v148, 0x3f803f80
    v_mov_b32 v33, 0
    v_mov_b32 v21, 0x7f000000
    v_mov_b32 v149, 0x3f803f80
    v_mov_b32 v34, 0
    v_mov_b32 v22, 0x7f000000
    v_mov_b32 v150, 0x3f803f80
    v_mov_b32 v35, 0
    v_mov_b32 v23, 0x7f000000
    v_mov_b32 v151, 0x3f803f80
    s_lshl_b32 s47, s76, 2
    s_add_u32 s47, s47, 0x262b0
    v_mov_b32 v16, s47
L_k_poll_hq13:
    ds_read_b128 v[8:11], v0 offset:16
    s_waitcnt lgkmcnt(0)
    v_min3_u32 v8, v8, v9, v10
    v_min_u32 v8, v8, v11
    v_cmp_gt_u32 vcc, 0x3e9, v8
    s_cbranch_vccz L_k_pok_hq13
    s_sleep 4
    s_sub_u32 s80, s80, 1
    s_cbranch_scc0 L_k_poll_hq13
    s_endpgm
L_k_pok_hq13:
    v_lshlrev_b32 v5, 4, v1
    v_add_u32 v5, 0x26380, v5
    ds_read_b128 v[68:71], v5 offset:0
    ds_read_b128 v[72:75], v5 offset:1024
    ds_read_b128 v[76:79], v5 offset:2048
    ds_read_b128 v[80:83], v5 offset:3072
    s_mov_b32 s52, 2
    s_mov_b32 s54, 0
L_k_h_loop:
L_k_poll_hkv:
    ds_read_b64 v[8:9], v0 offset:8
    s_waitcnt lgkmcnt(0)
    v_min_u32 v8, v8, v9
    v_cmp_gt_u32 vcc, s52, v8
    s_cbranch_vccz L_k_pok_hkv
    s_sleep 4
    s_sub_u32 s80, s80, 1
    s_cbranch_scc0 L_k_poll_hkv
    s_endpgm
L_k_pok_hkv:
    ds_read_b128 v[84:87], v2 offset:0
    ds_read_b128 v[88:91], v2 offset:64
    ds_read_b128 v[92:95], v2 offset:128
    ds_read_b128 v[96:99], v2 offset:192
    ds_read_b128 v[100:103], v2 offset:512
    ds_read_b128 v[104:107], v2 offset:576
    ds_read_b128 v[108:111], v2 offset:640
    ds_read_b128 v[112:115], v2 offset:704
    ds_read_b64_tr_b16 v[116:117], v3 offset:0
    ds_read_b64_tr_b16 v[118:119], v3 offset:512
    ds_read_b64_tr_b16 v[120:121], v3 offset:32
    ds_read_b64_tr_b16 v[122:123], v3 offset:544
    ds_read_b64_tr_b16 v[124:125], v3 offset:64
    ds_read_b64_tr_b16 v[126:127], v3 offset:576
    ds_read_b64_tr_b16 v[128:129], v3 offset:96
    ds_read_b64_tr_b16 v[130:131], v3 offset:608
    ds_read_b64_tr_b16 v[132:133], v3 offset:128
    ds_read_b64_tr_b16 v[134:135], v3 offset:640
    ds_read_b64_tr_b16 v[136:137], v3 offset:160
    ds_read_b64_tr_b16 v[138:139], v3 offset:672
    ds_read_b64_tr_b16 v[140:141], v3 offset:192
    ds_read_b64_tr_b16 v[142:143], v3 offset:704
    ds_read_b64_tr_b16 v[144:145], v3 offset:224
    ds_read_b64_tr_b16 v[146:147], v3 offset:736
    v_mov_b32 v17, s52
    ds_write_b32 v16, v17
    s_waitcnt lgkmcnt(15)
    v_mfma_f32_16x16x32_bf16 v[24:27], v[84:87], v[68:71], v[20:23]
    v_mfma_f32_16x16x32_bf16 v[24:27], v[88:91], v[72:75], v[24:27]
    v_mfma_f32_16x16x32_bf16 v[24:27], v[92:95], v[76:79], v[24:27]
    v_mfma_f32_16x16x32_bf16 v[24:27], v[96:99], v[80:83], v[24:27]
    v_mfma_f32_16x16x32_bf16 v[28:31], v[100:103], v[68:71], v[20:23]
    v_mfma_f32_16x16x32_bf16 v[28:31], v[104:107], v[72:75], v[28:31]
    v_mfma_f32_16x16x32_bf16 v[28:31], v[108:111], v[76:79], v[28:31]
    v_mfma_f32_16x16x32_bf16 v[28:31], v[112:115], v[80:83], v[28:31]
    s_add_u32 s54, s54, 2
    s_cmp_ge_u32 s54, 9
    s_cselect_b32 s56, 0xfffe3200, s77
    s_cselect_b32 s47, 9, 0
    s_sub_u32 s54, s54, s47
    s_add_u32 s47, s54, 1
    s_cmp_ge_u32 s47, 9
    s_cselect_b32 s47, 0, s47
    s_cmp_lt_u32 s47, 2
    s_cselect_b32 s57, 0xfffe3200, s77
    v_exp_f32 v24, v24
    v_exp_f32 v25, v25
    v_exp_f32 v26, v26
    v_exp_f32 v27, v27
    v_exp_f32 v28, v28
    v_exp_f32 v29, v29
    v_exp_f32 v30, v30
    v_exp_f32 v31, v31
    v_cvt_pk_bf16_f32 v24, v24, v25
    v_cvt_pk_bf16_f32 v25, v26, v27
    v_cvt_pk_bf16_f32 v26, v28, v29
    v_cvt_pk_bf16_f32 v27, v30, v31
    v_or3_b32 v5, v24, v25, v26
    v_or_b32 v5, v5, v27
    v_and_b32 v5, 0x40004000, v5
    v_cmp_ne_u32 vcc, 0, v5
    s_cbranch_vccnz L_k_h_rare
L_k_h_ret:
    v_mfma_f32_16x16x32_bf16 v[32:35], v[148:151], v[24:27], v[32:35]
    v_mfma_f32_16x16x32_bf16 v[36:39], v[116:119], v[24:27], v[36:39]
    s_waitcnt lgkmcnt(13)
    v_mfma_f32_16x16x32_bf16 v[40:43], v[120:123], v[24:27], v[40:43]
    s_waitcnt lgkmcnt(11)
    v_mfma_f32_16x16x32_bf16 v[44:47], v[124:127], v[24:27], v[44:47]
    s_waitcnt lgkmcnt(9)
    v_mfma_f32_16x16x32_bf16 v[48:51], v[128:131], v[24:27], v[48:51]
    s_waitcnt lgkmcnt(7)
    v_mfma_f32_16x16x32_bf16 v[52:55], v[132:135], v[24:27], v[52:55]
    s_waitcnt lgkmcnt(5)
    v_mfma_f32_16x16x32_bf16 v[56:59], v[136:139], v[24:27], v[56:59]
    s_waitcnt lgkmcnt(3)
    v_mfma_f32_16x16x32_bf16 v[60:63], v[140:143], v[24:27], v[60:63]
    s_waitcnt lgkmcnt(1)
    v_mfma_f32_16x16x32_bf16 v[64:67], v[144:147], v[24:27], v[64:67]
    v_add_u32 v2, s56, v2
    v_add_u32 v3, s57, v3
    s_add_u32 s52, s52, 2
    s_cmp_le_u32 s52, 16
    s_cbranch_scc1 L_k_h_loop
    v_lshlrev_b32 v5, 4, v1
    s_cmp_eq_u32 s76, 0
    s_cbranch_scc0 L_k_hf1
    v_add_u32 v6, 0x25200, v5
    ds_write_b128 v6, v[52:55] offset:0
    ds_write_b128 v6, v[56:59] offset:1024
    ds_write_b128 v6, v[60:63] offset:2048
    ds_write_b128 v6, v[64:67] offset:3072
    v_add_u32 v6, 0x26380, v5
    s_branch L_k_hf2
L_k_hf1:
    v_add_u32 v6, 0x26380, v5
    ds_write_b128 v6, v[36:39] offset:0
    ds_write_b128 v6, v[40:43] offset:1024
    ds_write_b128 v6, v[44:47] offset:2048
    ds_write_b128 v6, v[48:51] offset:3072
    v_mov_b32 v36, v52
    v_mov_b32 v37, v53
    v_mov_b32 v38, v54
    v_mov_b32 v39, v55
    v_mov_b32 v40, v56
    v_mov_b32 v41, v57
    v_mov_b32 v42, v58
    v_mov_b32 v43, v59
    v_mov_b32 v44, v60
    v_mov_b32 v45, v61
    v_mov_b32 v46, v62
    v_mov_b32 v47, v63
    v_mov_b32 v48, v64
    v_mov_b32 v49, v65
    v_mov_b32 v50, v66
    v_mov_b32 v51, v67
    v_add_u32 v6, 0x25200, v5
L_k_hf2:
    v_lshlrev_b32 v7, 3, v1
    s_lshl_b32 s47, s76, 9
    s_add_u32 s47, s47, 0x27380
    v_add_u32 v4, s47, v7
    v_mov_b32 v21, v32
    ds_write_b64 v4, v[20:21]
    s_lshl_b32 s47, s76, 2
    s_add_u32 s47, s47, 0x262c0
    v_mov_b32 v16, s47
    v_mov_b32 v17, 1
    ds_write_b32 v16, v17
L_k_poll_hfin:
    ds_read_b64 v[8:9], v0 offset:64
    s_waitcnt lgkmcnt(0)
    v_min_u32 v8, v8, v9
    v_cmp_gt_u32 vcc, 1, v8
    s_cbranch_vccz L_k_pok_hfin
    s_sub_u32 s80, s80, 1
    s_cbranch_scc0 L_k_poll_hfin
    s_endpgm
L_k_pok_hfin:
    s_xor_b32 s47, s76, 1
    s_lshl_b32 s47, s47, 9
    s_add_u32 s47, s47, 0x27380
    v_add_u32 v7, s47, v7
    ds_read_b64 v[68:69], v7
    ds_read_b128 v[84:87], v6 offset:0
    ds_read_b128 v[88:91], v6 offset:1024
    ds_read_b128 v[92:95], v6 offset:2048
    ds_read_b128 v[96:99], v6 offset:3072
    s_waitcnt lgkmcnt(4)
    v_min_f32 v7, v68, v20
    v_sub_f32 v68, v7, v68
    v_exp_f32 v68, v68
    v_sub_f32 v20, v7, v20
    v_exp_f32 v20, v20
    v_mul_f32 v4, v68, v69
    v_fmac_f32 v4, v20, v21
    v_rcp_f32 v4, v4
    s_nop 0
    v_mul_f32 v68, v68, v4
    v_mul_f32 v20, v20, v4
    v_mul_f32 v36, v36, v20
    s_waitcnt lgkmcnt(3)
    v_fmac_f32 v36, v84, v68
    v_mul_f32 v37, v37, v20
    v_fmac_f32 v37, v85, v68
    v_mul_f32 v38, v38, v20
    v_fmac_f32 v38, v86, v68
    v_mul_f32 v39, v39, v20
    v_fmac_f32 v39, v87, v68
    v_mul_f32 v40, v40, v20
    s_waitcnt lgkmcnt(2)
    v_fmac_f32 v40, v88, v68
    v_mul_f32 v41, v41, v20
    v_fmac_f32 v41, v89, v68
    v_mul_f32 v42, v42, v20
    v_fmac_f32 v42, v90, v68
    v_mul_f32 v43, v43, v20
    v_fmac_f32 v43, v91, v68
    v_mul_f32 v44, v44, v20
    s_waitcnt lgkmcnt(1)
    v_fmac_f32 v44, v92, v68
    v_mul_f32 v45, v45, v20
    v_fmac_f32 v45, v93, v68
    v_mul_f32 v46, v46, v20
    v_fmac_f32 v46, v94, v68
    v_mul_f32 v47, v47, v20
    v_fmac_f32 v47, v95, v68
    v_mul_f32 v48, v48, v20
    s_waitcnt lgkmcnt(0)
    v_fmac_f32 v48, v96, v68
    v_mul_f32 v49, v49, v20
    v_fmac_f32 v49, v97, v68
    v_mul_f32 v50, v50, v20
    v_fmac_f32 v50, v98, v68
    v_mul_f32 v51, v51, v20
    v_fmac_f32 v51, v99, v68
    s_lshl_b32 s47, s76, 11
    s_lshl_b32 s48, s81, 12
    s_add_u32 s47, s47, s48
    s_add_u32 s47, s47, 0x180000
    v_cvt_pk_bf16_f32 v36, v36, v37
    v_cvt_pk_bf16_f32 v37, v38, v39
    v_cvt_pk_bf16_f32 v38, v40, v41
    v_cvt_pk_bf16_f32 v39, v42, v43
    buffer_store_dwordx4 v[36:39], v5, s[16:19], s47 offen offset:0 sc1
    v_cvt_pk_bf16_f32 v44, v44, v45
    v_cvt_pk_bf16_f32 v45, v46, v47
    v_cvt_pk_bf16_f32 v46, v48, v49
    v_cvt_pk_bf16_f32 v47, v50, v51
    buffer_store_dwordx4 v[44:47], v5, s[16:19], s47 offen offset:1024 sc1
    s_lshl_b32 s47, s81, 2
    s_add_u32 s49, s47, s83
    s_waitcnt vmcnt(0)
    v_mov_b32 v5, 1
    s_mov_b64 exec, 1
    ds_add_rtn_u32 v6, v0, v5 offset:96
    s_waitcnt lgkmcnt(0)
    v_cmp_eq_u32 vcc, 5, v6
    s_cbranch_vccz L_k_arr_h1
L_k_poll_nonceh1:
    ds_read_b32 v5, v0 offset:116
    s_waitcnt lgkmcnt(0)
    v_cmp_gt_u32 vcc, 1, v5
    s_cbranch_vccz L_k_pok_nonceh1
    s_sleep 1
    s_sub_u32 s80, s80, 1
    s_cbranch_scc0 L_k_poll_nonceh1
    s_endpgm
L_k_pok_nonceh1:
    v_mov_b32 v6, s49
    buffer_store_dword v5, v6, s[72:75], 0 offen sc1
L_k_arr_h1:
    s_mov_b64 exec, -1
    s_cmp_eq_u32 s76, 1
    s_cbranch_scc0 L_k_h_p3
L_k_poll_wn1:
    ds_read_b32 v7, v0 offset:116
    s_waitcnt lgkmcnt(0)
    v_cmp_gt_u32 vcc, 1, v7
    s_cbranch_vccz L_k_pok_wn1
    s_sleep 1
    s_sub_u32 s80, s80, 1
    s_cbranch_scc0 L_k_poll_wn1
    s_endpgm
L_k_pok_wn1:
    s_add_u32 s47, s81, 1
    v_add_u32 v6, s47, v1
    v_and_b32 v6, 7, v6
    v_lshlrev_b32 v6, 2, v6
    v_add_u32 v6, s83, v6
    s_mov_b64 exec, 0x7f
L_k_w1:
    buffer_load_dword v5, v6, s[72:75], 0 offen sc1
    s_waitcnt vmcnt(0)
    v_cmp_ne_u32 vcc, v5, v7
    s_nop 2
    s_or_b32 s47, vcc_lo, 0x80
    s_ff1_i32_b32 s47, s47
    v_mov_b32 v5, s47
    ds_write_b32 v0, v5 offset:112
    s_cmp_eq_u32 s47, 7
    s_cbranch_scc1 L_k_w1ok
    s_sleep 2
    s_sub_u32 s80, s80, 1
    s_cbranch_scc0 L_k_w1
    s_endpgm
L_k_w1ok:
    s_mov_b64 exec, -1
    s_branch L_k_h_p3
L_k_h23:
    v_lshlrev_b32 v20, 4, v1
    s_lshl_b32 s47, s76, 13
    v_add_u32 v20, s47, v20
    s_lshl_b32 s47, s45, 5
    s_add_u32 s47, s47, s46
    s_lshl_b32 s47, s47, 17
    s_waitcnt lgkmcnt(0)
    s_add_u32 s8, s30, s47
    s_addc_u32 s9, s31, 0
    s_mov_b32 s10, 0x20000
    s_mov_b32 s11, 0x20000
    s_add_u32 s12, s32, s47
    s_addc_u32 s13, s33, 0
    s_mov_b32 s14, 0x20000
    s_mov_b32 s15, 0x20000
    s_barrier
    v_and_b32 v5, 15, v1
    v_lshlrev_b32 v5, 4, v5
    v_lshrrev_b32 v6, 4, v1
    v_mul_u32_u24 v6, 0x420, v6
    v_add_u32 v21, v5, v6
    s_mul_i32 s47, s76, 0x2100
    v_add_u32 v21, s47, v21
    s_lshl_b32 s47, s76, 2
    s_add_u32 s47, s47, 0x26288
    v_mov_b32 v16, s47
    s_mul_i32 s47, s45, 0x1a0000
    s_lshl_b32 s48, s82, 15
    s_add_u32 s47, s47, s48
    s_add_u32 s16, s42, s47
    s_addc_u32 s17, s43, 0
    s_sub_u32 s18, 0x1a0000, s48
    s_mov_b32 s19, 0x20000
    s_lshl_b32 s47, s45, 3
    s_add_u32 s47, s47, s81
    s_lshl_b32 s84, s47, 7
    s_mul_i32 s47, s47, 0x34000
    s_add_u32 s47, s47, 0x1000000
    s_add_u32 s20, s42, s47
    s_addc_u32 s21, s43, 0
    s_mov_b32 s22, 0x34000
    s_mov_b32 s23, 0x20000
    s_mul_i32 s47, s45, 0x34000
    s_lshl_b32 s48, s81, 7
    s_add_u32 s47, s47, s48
    s_add_u32 s24, s38, s47
    s_addc_u32 s25, s39, 0
    s_sub_u32 s26, 0x1a0000, s47
    s_mov_b32 s27, 0x20000
    s_add_u32 s72, s42, 0x2000000
    s_addc_u32 s73, s43, 0
    s_mov_b32 s74, 0x10000
    s_mov_b32 s75, 0x20000
    s_lshl_b32 s47, s45, 2
    s_add_u32 s47, s47, s82
    s_add_u32 s47, s47, 64
    s_lshl_b32 s83, s47, 7
    s_lshl_b32 s47, s82, 20
    s_lshl_b32 s48, s81, 7
    s_add_u32 s47, s47, s48
    s_add_u32 s64, s36, s47
    s_addc_u32 s65, s37, 0
    s_sub_u32 s66, 0x400000, s47
    s_mov_b32 s67, 0x20000
    s_add_u32 s68, s40, 0
    s_addc_u32 s69, s41, 0
    s_mov_b32 s70, 0x100
    s_mov_b32 s71, 0x20000
    s_xor_b32 s47, s76, 1
    s_or_b32 s47, s47, s46
    s_cmp_eq_u32 s47, 0
    s_cbranch_scc0 L_k_nonw
    s_memrealtime s[4:5]
    s_waitcnt lgkmcnt(0)
    s_or_b32 s47, s4, 1
    s_lshl_b32 s48, s45, 5
    s_mov_b64 exec, 1
    v_mov_b32 v8, s47
    v_mov_b32 v5, s48
    buffer_store_dword v8, v5, s[68:71], 0 offen sc1
    s_mov_b64 exec, -1
L_k_nonw:
L_k_poll_kvres:
    ds_read_b32 v8, v0 offset:120
    s_waitcnt lgkmcnt(0)
    v_cmp_gt_u32 vcc, 1, v8
    s_cbranch_vccz L_k_pok_kvres
    s_sleep 2
    s_sub_u32 s80, s80, 1
    s_cbranch_scc0 L_k_poll_kvres
    s_endpgm
L_k_pok_kvres:
    s_mov_b32 s62, 0
    buffer_load_dwordx4 v[24:27], v20, s[8:11], s62 offen offset:0 nt
    buffer_load_dwordx4 v[28:31], v20, s[8:11], s62 offen offset:1024 nt
    buffer_load_dwordx4 v[32:35], v20, s[8:11], s62 offen offset:2048 nt
    buffer_load_dwordx4 v[36:39], v20, s[8:11], s62 offen offset:3072 nt
    s_mov_b32 s62, 0x1000
    buffer_load_dwordx4 v[40:43], v20, s[8:11], s62 offen offset:0 nt
    buffer_load_dwordx4 v[44:47], v20, s[8:11], s62 offen offset:1024 nt
    buffer_load_dwordx4 v[48:51], v20, s[8:11], s62 offen offset:2048 nt
    buffer_load_dwordx4 v[52:55], v20, s[8:11], s62 offen offset:3072 nt
    s_mov_b32 s62, 0
    buffer_load_dwordx4 v[56:59], v20, s[12:15], s62 offen offset:0 nt
    buffer_load_dwordx4 v[60:63], v20, s[12:15], s62 offen offset:1024 nt
    buffer_load_dwordx4 v[64:67], v20, s[12:15], s62 offen offset:2048 nt
    buffer_load_dwordx4 v[68:71], v20, s[12:15], s62 offen offset:3072 nt
    s_mov_b32 s62, 0x1000
    buffer_load_dwordx4 v[72:75], v20, s[12:15], s62 offen offset:0 nt
    buffer_load_dwordx4 v[76:79], v20, s[12:15], s62 offen offset:1024 nt
    buffer_load_dwordx4 v[80:83], v20, s[12:15], s62 offen offset:2048 nt
    buffer_load_dwordx4 v[84:87], v20, s[12:15], s62 offen offset:3072 nt
    s_waitcnt vmcnt(16)
    s_mov_b32 s62, 0x4000
    buffer_load_dwordx4 v[88:91], v20, s[8:11], s62 offen offset:0 nt
    buffer_load_dwordx4 v[92:95], v20, s[8:11], s62 offen offset:1024 nt
    buffer_load_dwordx4 v[96:99], v20, s[8:11], s62 offen offset:2048 nt
    buffer_load_dwordx4 v[100:103], v20, s[8:11], s62 offen offset:3072 nt
    s_mov_b32 s62, 0x5000
    buffer_load_dwordx4 v[104:107], v20, s[8:11], s62 offen offset:0 nt
    buffer_load_dwordx4 v[108:111], v20, s[8:11], s62 offen offset:1024 nt
    buffer_load_dwordx4 v[112:115], v20, s[8:11], s62 offen offset:2048 nt
    buffer_load_dwordx4 v[116:119], v20, s[8:11], s62 offen offset:3072 nt
    s_waitcnt vmcnt(16)
    s_mov_b32 s62, 0x4000
    buffer_load_dwordx4 v[120:123], v20, s[12:15], s62 offen offset:0 nt
    buffer_load_dwordx4 v[124:127], v20, s[12:15], s62 offen offset:1024 nt
    buffer_load_dwordx4 v[128:131], v20, s[12:15], s62 offen offset:2048 nt
    buffer_load_dwordx4 v[132:135], v20, s[12:15], s62 offen offset:3072 nt
    s_mov_b32 s62, 0x5000
    buffer_load_dwordx4 v[136:139], v20, s[12:15], s62 offen offset:0 nt
    buffer_load_dwordx4 v[140:143], v20, s[12:15], s62 offen offset:1024 nt
    buffer_load_dwordx4 v[144:147], v20, s[12:15], s62 offen offset:2048 nt
    buffer_load_dwordx4 v[148:151], v20, s[12:15], s62 offen offset:3072 nt
L_k_poll_fwq:
    ds_read_b128 v[8:11], v0 offset:16
    s_waitcnt lgkmcnt(0)
    v_min3_u32 v8, v8, v9, v10
    v_min_u32 v8, v8, v11
    v_cmp_gt_u32 vcc, 0x3e8, v8
    s_cbranch_vccz L_k_pok_fwq
    s_sleep 1
    s_sub_u32 s80, s80, 1
    s_cbranch_scc0 L_k_poll_fwq
    s_endpgm
L_k_pok_fwq:
    v_add_u32 v22, 0, v21
    ds_write_b128 v22, v[24:27] offset:0
    ds_write_b128 v22, v[28:31] offset:4224
    ds_write_b128 v22, v[32:35] offset:256
    ds_write_b128 v22, v[36:39] offset:4480
    ds_write_b128 v22, v[40:43] offset:512
    ds_write_b128 v22, v[44:47] offset:4736
    ds_write_b128 v22, v[48:51] offset:768
    ds_write_b128 v22, v[52:55] offset:4992
    v_mov_b32 v17, 1
    ds_write_b32 v16, v17
    v_add_u32 v22, 0x4200, v21
    s_waitcnt vmcnt(23)
    ds_write_b128 v22, v[56:59] offset:0
    s_waitcnt vmcnt(22)
    ds_write_b128 v22, v[60:63] offset:4224
    s_waitcnt vmcnt(21)
    ds_write_b128 v22, v[64:67] offset:256
    s_waitcnt vmcnt(20)
    ds_write_b128 v22, v[68:71] offset:4480
    s_waitcnt vmcnt(19)
    ds_write_b128 v22, v[72:75] offset:512
    s_waitcnt vmcnt(18)
    ds_write_b128 v22, v[76:79] offset:4736
    s_waitcnt vmcnt(17)
    ds_write_b128 v22, v[80:83] offset:768
    s_waitcnt vmcnt(16)
    ds_write_b128 v22, v[84:87] offset:4992
    v_mov_b32 v17, 2
    ds_write_b32 v16, v17
    s_waitcnt vmcnt(16)
    s_mov_b32 s62, 0x8000
    buffer_load_dwordx4 v[152:155], v20, s[8:11], s62 offen offset:0 nt
    buffer_load_dwordx4 v[156:159], v20, s[8:11], s62 offen offset:1024 nt
    buffer_load_dwordx4 v[160:163], v20, s[8:11], s62 offen offset:2048 nt
    buffer_load_dwordx4 v[164:167], v20, s[8:11], s62 offen offset:3072 nt
    s_mov_b32 s62, 0x9000
    buffer_load_dwordx4 v[168:171], v20, s[8:11], s62 offen offset:0 nt
    buffer_load_dwordx4 v[172:175], v20, s[8:11], s62 offen offset:1024 nt
    buffer_load_dwordx4 v[176:179], v20, s[8:11], s62 offen offset:2048 nt
    buffer_load_dwordx4 v[180:183], v20, s[8:11], s62 offen offset:3072 nt
    v_add_u32 v22, 0x8400, v21
    s_waitcnt vmcnt(23)
    ds_write_b128 v22, v[88:91] offset:0
    s_waitcnt vmcnt(22)
    ds_write_b128 v22, v[92:95] offset:4224
    s_waitcnt vmcnt(21)
    ds_write_b128 v22, v[96:99] offset:256
    s_waitcnt vmcnt(20)
    ds_write_b128 v22, v[100:103] offset:4480
    s_waitcnt vmcnt(19)
    ds_write_b128 v22, v[104:107] offset:512
    s_waitcnt vmcnt(18)
    ds_write_b128 v22, v[108:111] offset:4736
    s_waitcnt vmcnt(17)
    ds_write_b128 v22, v[112:115] offset:768
    s_waitcnt vmcnt(16)
    ds_write_b128 v22, v[116:119] offset:4992
    v_mov_b32 v17, 3
    ds_write_b32 v16, v17
    s_waitcnt vmcnt(16)
    s_mov_b32 s62, 0x8000
    buffer_load_dwordx4 a[0:3], v20, s[12:15], s62 offen offset:0 nt
    buffer_load_dwordx4 a[4:7], v20, s[12:15], s62 offen offset:1024 nt
    buffer_load_dwordx4 a[8:11], v20, s[12:15], s62 offen offset:2048 nt
    buffer_load_dwordx4 a[12:15], v20, s[12:15], s62 offen offset:3072 nt
    s_mov_b32 s62, 0x9000
    buffer_load_dwordx4 a[16:19], v20, s[12:15], s62 offen offset:0 nt
    buffer_load_dwordx4 a[20:23], v20, s[12:15], s62 offen offset:1024 nt
    buffer_load_dwordx4 a[24:27], v20, s[12:15], s62 offen offset:2048 nt
    buffer_load_dwordx4 a[28:31], v20, s[12:15], s62 offen offset:3072 nt
    v_add_u32 v22, 0xc600, v21
    s_waitcnt vmcnt(23)
    ds_write_b128 v22, v[120:123] offset:0
    s_waitcnt vmcnt(22)
    ds_write_b128 v22, v[124:127] offset:4224
    s_waitcnt vmcnt(21)
    ds_write_b128 v22, v[128:131] offset:256
    s_waitcnt vmcnt(20)
    ds_write_b128 v22, v[132:135] offset:4480
    s_waitcnt vmcnt(19)
    ds_write_b128 v22, v[136:139] offset:512
    s_waitcnt vmcnt(18)
    ds_write_b128 v22, v[140:143] offset:4736
    s_waitcnt vmcnt(17)
    ds_write_b128 v22, v[144:147] offset:768
    s_waitcnt vmcnt(16)
    ds_write_b128 v22, v[148:151] offset:4992
    v_mov_b32 v17, 4
    ds_write_b32 v16, v17
    s_waitcnt vmcnt(16)
    s_mov_b32 s62, 0xc000
    buffer_load_dwordx4 v[24:27], v20, s[8:11], s62 offen offset:0 nt
    buffer_load_dwordx4 v[28:31], v20, s[8:11], s62 offen offset:1024 nt
    buffer_load_dwordx4 v[32:35], v20, s[8:11], s62 offen offset:2048 nt
    buffer_load_dwordx4 v[36:39], v20, s[8:11], s62 offen offset:3072 nt
    s_mov_b32 s62, 0xd000
    buffer_load_dwordx4 v[40:43], v20, s[8:11], s62 offen offset:0 nt
    buffer_load_dwordx4 v[44:47], v20, s[8:11], s62 offen offset:1024 nt
    buffer_load_dwordx4 v[48:51], v20, s[8:11], s62 offen offset:2048 nt
    buffer_load_dwordx4 v[52:55], v20, s[8:11], s62 offen offset:3072 nt
    v_add_u32 v22, 0x10800, v21
    s_waitcnt vmcnt(23)
    ds_write_b128 v22, v[152:155] offset:0
    s_waitcnt vmcnt(22)
    ds_write_b128 v22, v[156:159] offset:4224
    s_waitcnt vmcnt(21)
    ds_write_b128 v22, v[160:163] offset:256
    s_waitcnt vmcnt(20)
    ds_write_b128 v22, v[164:167] offset:4480
    s_waitcnt vmcnt(19)
    ds_write_b128 v22, v[168:171] offset:512
    s_waitcnt vmcnt(18)
    ds_write_b128 v22, v[172:175] offset:4736
    s_waitcnt vmcnt(17)
    ds_write_b128 v22, v[176:179] offset:768
    s_waitcnt vmcnt(16)
    ds_write_b128 v22, v[180:183] offset:4992
    v_mov_b32 v17, 5
    ds_write_b32 v16, v17
L_k_poll_thr7:
    ds_read_b128 v[8:11], v0 offset:32
    s_waitcnt lgkmcnt(0)
    v_min3_u32 v8, v8, v9, v10
    v_min_u32 v8, v8, v11
    v_cmp_gt_u32 vcc, 1, v8
    s_cbranch_vccz L_k_pok_thr7
    s_sleep 2
    s_sub_u32 s80, s80, 1
    s_cbranch_scc0 L_k_poll_thr7
    s_endpgm
L_k_pok_thr7:
    s_waitcnt vmcnt(16)
    s_mov_b32 s62, 0xc000
    buffer_load_dwordx4 v[56:59], v20, s[12:15], s62 offen offset:0 nt
    buffer_load_dwordx4 v[60:63], v20, s[12:15], s62 offen offset:1024 nt
    buffer_load_dwordx4 v[64:67], v20, s[12:15], s62 offen offset:2048 nt
    buffer_load_dwordx4 v[68:71], v20, s[12:15], s62 offen offset:3072 nt
    s_mov_b32 s62, 0xd000
    buffer_load_dwordx4 v[72:75], v20, s[12:15], s62 offen offset:0 nt
    buffer_load_dwordx4 v[76:79], v20, s[12:15], s62 offen offset:1024 nt
    buffer_load_dwordx4 v[80:83], v20, s[12:15], s62 offen offset:2048 nt
    buffer_load_dwordx4 v[84:87], v20, s[12:15], s62 offen offset:3072 nt
    v_add_u32 v22, 0x14a00, v21
    s_waitcnt vmcnt(23)
    ds_write_b128 v22, a[0:3] offset:0
    s_waitcnt vmcnt(22)
    ds_write_b128 v22, a[4:7] offset:4224
    s_waitcnt vmcnt(21)
    ds_write_b128 v22, a[8:11] offset:256
    s_waitcnt vmcnt(20)
    ds_write_b128 v22, a[12:15] offset:4480
    s_waitcnt vmcnt(19)
    ds_write_b128 v22, a[16:19] offset:512
    s_waitcnt vmcnt(18)
    ds_write_b128 v22, a[20:23] offset:4736
    s_waitcnt vmcnt(17)
    ds_write_b128 v22, a[24:27] offset:768
    s_waitcnt vmcnt(16)
    ds_write_b128 v22, a[28:31] offset:4992
    v_mov_b32 v17, 6
    ds_write_b32 v16, v17
L_k_poll_thr8:
    ds_read_b128 v[8:11], v0 offset:32
    s_waitcnt lgkmcnt(0)
    v_min3_u32 v8, v8, v9, v10
    v_min_u32 v8, v8, v11
    v_cmp_gt_u32 vcc, 2, v8
    s_cbranch_vccz L_k_pok_thr8
    s_sleep 2
    s_sub_u32 s80, s80, 1
    s_cbranch_scc0 L_k_poll_thr8
    s_endpgm
L_k_pok_thr8:
    s_waitcnt vmcnt(16)
    s_mov_b32 s62, 0x10000
    buffer_load_dwordx4 v[88:91], v20, s[8:11], s62 offen offset:0 nt
    buffer_load_dwordx4 v[92:95], v20, s[8:11], s62 offen offset:1024 nt
    buffer_load_dwordx4 v[96:99], v20, s[8:11], s62 offen offset:2048 nt
    buffer_load_dwordx4 v[100:103], v20, s[8:11], s62 offen offset:3072 nt
    s_mov_b32 s62, 0x11000
    buffer_load_dwordx4 v[104:107], v20, s[8:11], s62 offen offset:0 nt
    buffer_load_dwordx4 v[108:111], v20, s[8:11], s62 offen offset:1024 nt
    buffer_load_dwordx4 v[112:115], v20, s[8:11], s62 offen offset:2048 nt
    buffer_load_dwordx4 v[116:119], v20, s[8:11], s62 offen offset:3072 nt
    v_add_u32 v22, 0x18c00, v21
    s_waitcnt vmcnt(23)
    ds_write_b128 v22, v[24:27] offset:0
    s_waitcnt vmcnt(22)
    ds_write_b128 v22, v[28:31] offset:4224
    s_waitcnt vmcnt(21)
    ds_write_b128 v22, v[32:35] offset:256
    s_waitcnt vmcnt(20)
    ds_write_b128 v22, v[36:39] offset:4480
    s_waitcnt vmcnt(19)
    ds_write_b128 v22, v[40:43] offset:512
    s_waitcnt vmcnt(18)
    ds_write_b128 v22, v[44:47] offset:4736
    s_waitcnt vmcnt(17)
    ds_write_b128 v22, v[48:51] offset:768
    s_waitcnt vmcnt(16)
    ds_write_b128 v22, v[52:55] offset:4992
    v_mov_b32 v17, 7
    ds_write_b32 v16, v17
L_k_poll_thr9:
    ds_read_b128 v[8:11], v0 offset:32
    s_waitcnt lgkmcnt(0)
    v_min3_u32 v8, v8, v9, v10
    v_min_u32 v8, v8, v11
    v_cmp_gt_u32 vcc, 3, v8
    s_cbranch_vccz L_k_pok_thr9
    s_sleep 2
    s_sub_u32 s80, s80, 1
    s_cbranch_scc0 L_k_poll_thr9
    s_endpgm
L_k_pok_thr9:
    s_waitcnt vmcnt(16)
    s_mov_b32 s62, 0x10000
    buffer_load_dwordx4 v[120:123], v20, s[12:15], s62 offen offset:0 nt
    buffer_load_dwordx4 v[124:127], v20, s[12:15], s62 offen offset:1024 nt
    buffer_load_dwordx4 v[128:131], v20, s[12:15], s62 offen offset:2048 nt
    buffer_load_dwordx4 v[132:135], v20, s[12:15], s62 offen offset:3072 nt
    s_mov_b32 s62, 0x11000
    buffer_load_dwordx4 v[136:139], v20, s[12:15], s62 offen offset:0 nt
    buffer_load_dwordx4 v[140:143], v20, s[12:15], s62 offen offset:1024 nt
    buffer_load_dwordx4 v[144:147], v20, s[12:15], s62 offen offset:2048 nt
    buffer_load_dwordx4 v[148:151], v20, s[12:15], s62 offen offset:3072 nt
    v_add_u32 v22, 0x1ce00, v21
    s_waitcnt vmcnt(23)
    ds_write_b128 v22, v[56:59] offset:0
    s_waitcnt vmcnt(22)
    ds_write_b128 v22, v[60:63] offset:4224
    s_waitcnt vmcnt(21)
    ds_write_b128 v22, v[64:67] offset:256
    s_waitcnt vmcnt(20)
    ds_write_b128 v22, v[68:71] offset:4480
    s_waitcnt vmcnt(19)
    ds_write_b128 v22, v[72:75] offset:512
    s_waitcnt vmcnt(18)
    ds_write_b128 v22, v[76:79] offset:4736
    s_waitcnt vmcnt(17)
    ds_write_b128 v22, v[80:83] offset:768
    s_waitcnt vmcnt(16)
    ds_write_b128 v22, v[84:87] offset:4992
    v_mov_b32 v17, 8
    ds_write_b32 v16, v17
L_k_poll_thr10:
    ds_read_b128 v[8:11], v0 offset:32
    s_waitcnt lgkmcnt(0)
    v_min3_u32 v8, v8, v9, v10
    v_min_u32 v8, v8, v11
    v_cmp_gt_u32 vcc, 4, v8
    s_cbranch_vccz L_k_pok_thr10
    s_sleep 2
    s_sub_u32 s80, s80, 1
    s_cbranch_scc0 L_k_poll_thr10
    s_endpgm
L_k_pok_thr10:
    s_waitcnt vmcnt(16)
    s_mov_b32 s62, 0x14000
    buffer_load_dwordx4 v[152:155], v20, s[8:11], s62 offen offset:0 nt
    buffer_load_dwordx4 v[156:159], v20, s[8:11], s62 offen offset:1024 nt
    buffer_load_dwordx4 v[160:163], v20, s[8:11], s62 offen offset:2048 nt
    buffer_load_dwordx4 v[164:167], v20, s[8:11], s62 offen offset:3072 nt
    s_mov_b32 s62, 0x15000
    buffer_load_dwordx4 v[168:171], v20, s[8:11], s62 offen offset:0 nt
    buffer_load_dwordx4 v[172:175], v20, s[8:11], s62 offen offset:1024 nt
    buffer_load_dwordx4 v[176:179], v20, s[8:11], s62 offen offset:2048 nt
    buffer_load_dwordx4 v[180:183], v20, s[8:11], s62 offen offset:3072 nt
    v_add_u32 v22, 0x21000, v21
    s_waitcnt vmcnt(23)
    ds_write_b128 v22, v[88:91] offset:0
    s_waitcnt vmcnt(22)
    ds_write_b128 v22, v[92:95] offset:4224
    s_waitcnt vmcnt(21)
    ds_write_b128 v22, v[96:99] offset:256
    s_waitcnt vmcnt(20)
    ds_write_b128 v22, v[100:103] offset:4480
    s_waitcnt vmcnt(19)
    ds_write_b128 v22, v[104:107] offset:512
    s_waitcnt vmcnt(18)
    ds_write_b128 v22, v[108:111] offset:4736
    s_waitcnt vmcnt(17)
    ds_write_b128 v22, v[112:115] offset:768
    s_waitcnt vmcnt(16)
    ds_write_b128 v22, v[116:119] offset:4992
    v_mov_b32 v17, 9
    ds_write_b32 v16, v17
L_k_poll_thr11:
    ds_read_b128 v[8:11], v0 offset:32
    s_waitcnt lgkmcnt(0)
    v_min3_u32 v8, v8, v9, v10
    v_min_u32 v8, v8, v11
    v_cmp_gt_u32 vcc, 5, v8
    s_cbranch_vccz L_k_pok_thr11
    s_sleep 2
    s_sub_u32 s80, s80, 1
    s_cbranch_scc0 L_k_poll_thr11
    s_endpgm
L_k_pok_thr11:
    s_waitcnt vmcnt(16)
    s_mov_b32 s62, 0x14000
    buffer_load_dwordx4 a[0:3], v20, s[12:15], s62 offen offset:0 nt
    buffer_load_dwordx4 a[4:7], v20, s[12:15], s62 offen offset:1024 nt
    buffer_load_dwordx4 a[8:11], v20, s[12:15], s62 offen offset:2048 nt
    buffer_load_dwordx4 a[12:15], v20, s[12:15], s62 offen offset:3072 nt
    s_mov_b32 s62, 0x15000
    buffer_load_dwordx4 a[16:19], v20, s[12:15], s62 offen offset:0 nt
    buffer_load_dwordx4 a[20:23], v20, s[12:15], s62 offen offset:1024 nt
    buffer_load_dwordx4 a[24:27], v20, s[12:15], s62 offen offset:2048 nt
    buffer_load_dwordx4 a[28:31], v20, s[12:15], s62 offen offset:3072 nt
L_k_poll_fwk9:
    ds_read_b128 v[8:11], v0 offset:32
    ds_read_b64 v[12:13], v0 offset:48
    s_waitcnt lgkmcnt(0)
    v_min3_u32 v8, v8, v9, v10
    v_min3_u32 v8, v8, v11, v12
    v_min_u32 v8, v8, v13
    v_cmp_gt_u32 vcc, 1, v8
    s_cbranch_vccz L_k_pok_fwk9
    s_sleep 4
    s_sub_u32 s80, s80, 1
    s_cbranch_scc0 L_k_poll_fwk9
    s_endpgm
L_k_pok_fwk9:
    v_add_u32 v22, 0, v21
    s_waitcnt vmcnt(23)
    ds_write_b128 v22, v[120:123] offset:0
    s_waitcnt vmcnt(22)
    ds_write_b128 v22, v[124:127] offset:4224
    s_waitcnt vmcnt(21)
    ds_write_b128 v22, v[128:131] offset:256
    s_waitcnt vmcnt(20)
    ds_write_b128 v22, v[132:135] offset:4480
    s_waitcnt vmcnt(19)
    ds_write_b128 v22, v[136:139] offset:512
    s_waitcnt vmcnt(18)
    ds_write_b128 v22, v[140:143] offset:4736
    s_waitcnt vmcnt(17)
    ds_write_b128 v22, v[144:147] offset:768
    s_waitcnt vmcnt(16)
    ds_write_b128 v22, v[148:151] offset:4992
    v_mov_b32 v17, 10
    ds_write_b32 v16, v17
L_k_poll_thr12:
    ds_read_b128 v[8:11], v0 offset:32
    s_waitcnt lgkmcnt(0)
    v_min3_u32 v8, v8, v9, v10
    v_min_u32 v8, v8, v11
    v_cmp_gt_u32 vcc, 6, v8
    s_cbranch_vccz L_k_pok_thr12
    s_sleep 2
    s_sub_u32 s80, s80, 1
    s_cbranch_scc0 L_k_poll_thr12
    s_endpgm
L_k_pok_thr12:
    s_waitcnt vmcnt(16)
    s_mov_b32 s62, 0x18000
    buffer_load_dwordx4 v[24:27], v20, s[8:11], s62 offen offset:0 nt
    buffer_load_dwordx4 v[28:31], v20, s[8:11], s62 offen offset:1024 nt
    buffer_load_dwordx4 v[32:35], v20, s[8:11], s62 offen offset:2048 nt
    buffer_load_dwordx4 v[36:39], v20, s[8:11], s62 offen offset:3072 nt
    s_mov_b32 s62, 0x19000
    buffer_load_dwordx4 v[40:43], v20, s[8:11], s62 offen offset:0 nt
    buffer_load_dwordx4 v[44:47], v20, s[8:11], s62 offen offset:1024 nt
    buffer_load_dwordx4 v[48:51], v20, s[8:11], s62 offen offset:2048 nt
    buffer_load_dwordx4 v[52:55], v20, s[8:11], s62 offen offset:3072 nt
    v_and_b32 v5, 7, v1
    v_lshlrev_b32 v5, 4, v5
    v_bfe_u32 v6, v1, 3, 1
    v_lshl_add_u32 v5, v6, 10, v5
    v_lshrrev_b32 v6, 4, v1
    v_lshl_add_u32 v212, v6, 13, v5
    v_add_u32 v213, 0x3e0, v212
    v_add_u32 v214, 0x7c0, v212
    v_add_u32 v215, 0xba0, v212
    s_and_b32 s48, s45, 3
    s_lshl_b32 s48, s48, 1
    s_add_u32 s48, s48, s76
    s_lshl_b32 s48, s48, 17
    s_add_u32 s62, s48, 0
    buffer_load_dwordx4 a[32:35], v212, s[64:67], s62 offen offset:0
    buffer_load_dwordx4 a[32:35], v213, s[64:67], s62 offen offset:1056
    buffer_load_dwordx4 a[32:35], v214, s[64:67], s62 offen offset:2112
    buffer_load_dwordx4 a[32:35], v215, s[64:67], s62 offen offset:3168
    s_add_u32 s62, s48, 0x8000
    buffer_load_dwordx4 a[32:35], v212, s[64:67], s62 offen offset:0
    buffer_load_dwordx4 a[32:35], v213, s[64:67], s62 offen offset:1056
    buffer_load_dwordx4 a[32:35], v214, s[64:67], s62 offen offset:2112
    buffer_load_dwordx4 a[32:35], v215, s[64:67], s62 offen offset:3168
    s_add_u32 s62, s48, 0x10000
    buffer_load_dwordx4 a[32:35], v212, s[64:67], s62 offen offset:0
    buffer_load_dwordx4 a[32:35], v213, s[64:67], s62 offen offset:1056
    buffer_load_dwordx4 a[32:35], v214, s[64:67], s62 offen offset:2112
    buffer_load_dwordx4 a[32:35], v215, s[64:67], s62 offen offset:3168
    s_add_u32 s62, s48, 0x18000
    buffer_load_dwordx4 a[32:35], v212, s[64:67], s62 offen offset:0
    buffer_load_dwordx4 a[32:35], v213, s[64:67], s62 offen offset:1056
    buffer_load_dwordx4 a[32:35], v214, s[64:67], s62 offen offset:2112
    buffer_load_dwordx4 a[32:35], v215, s[64:67], s62 offen offset:3168
L_k_poll_fwk10:
    ds_read_b128 v[8:11], v0 offset:32
    ds_read_b64 v[12:13], v0 offset:48
    s_waitcnt lgkmcnt(0)
    v_min3_u32 v8, v8, v9, v10
    v_min3_u32 v8, v8, v11, v12
    v_min_u32 v8, v8, v13
    v_cmp_gt_u32 vcc, 2, v8
    s_cbranch_vccz L_k_pok_fwk10
    s_sleep 4
    s_sub_u32 s80, s80, 1
    s_cbranch_scc0 L_k_poll_fwk10
    s_endpgm
L_k_pok_fwk10:
    v_add_u32 v22, 0x4200, v21
    s_waitcnt vmcnt(39)
    ds_write_b128 v22, v[152:155] offset:0
    s_waitcnt vmcnt(38)
    ds_write_b128 v22, v[156:159] offset:4224
    s_waitcnt vmcnt(37)
    ds_write_b128 v22, v[160:163] offset:256
    s_waitcnt vmcnt(36)
    ds_write_b128 v22, v[164:167] offset:4480
    s_waitcnt vmcnt(35)
    ds_write_b128 v22, v[168:171] offset:512
    s_waitcnt vmcnt(34)
    ds_write_b128 v22, v[172:175] offset:4736
    s_waitcnt vmcnt(33)
    ds_write_b128 v22, v[176:179] offset:768
    s_waitcnt vmcnt(32)
    ds_write_b128 v22, v[180:183] offset:4992
    v_mov_b32 v17, 11
    ds_write_b32 v16, v17
L_k_poll_thr13:
    ds_read_b128 v[8:11], v0 offset:32
    s_waitcnt lgkmcnt(0)
    v_min3_u32 v8, v8, v9, v10
    v_min_u32 v8, v8, v11
    v_cmp_gt_u32 vcc, 7, v8
    s_cbranch_vccz L_k_pok_thr13
    s_sleep 2
    s_sub_u32 s80, s80, 1
    s_cbranch_scc0 L_k_poll_thr13
    s_endpgm
L_k_pok_thr13:
    s_waitcnt vmcnt(16)
    s_mov_b32 s62, 0x18000
    buffer_load_dwordx4 v[56:59], v20, s[12:15], s62 offen offset:0 nt
    buffer_load_dwordx4 v[60:63], v20, s[12:15], s62 offen offset:1024 nt
    buffer_load_dwordx4 v[64:67], v20, s[12:15], s62 offen offset:2048 nt
    buffer_load_dwordx4 v[68:71], v20, s[12:15], s62 offen offset:3072 nt
    s_mov_b32 s62, 0x19000
    buffer_load_dwordx4 v[72:75], v20, s[12:15], s62 offen offset:0 nt
    buffer_load_dwordx4 v[76:79], v20, s[12:15], s62 offen offset:1024 nt
    buffer_load_dwordx4 v[80:83], v20, s[12:15], s62 offen offset:2048 nt
    buffer_load_dwordx4 v[84:87], v20, s[12:15], s62 offen offset:3072 nt
L_k_poll_fwk11:
    ds_read_b128 v[8:11], v0 offset:32
    ds_read_b64 v[12:13], v0 offset:48
    s_waitcnt lgkmcnt(0)
    v_min3_u32 v8, v8, v9, v10
    v_min3_u32 v8, v8, v11, v12
    v_min_u32 v8, v8, v13
    v_cmp_gt_u32 vcc, 3, v8
    s_cbranch_vccz L_k_pok_fwk11
    s_sleep 4
    s_sub_u32 s80, s80, 1
    s_cbranch_scc0 L_k_poll_fwk11
    s_endpgm
L_k_pok_fwk11:
    v_add_u32 v22, 0x8400, v21
    ds_write_b128 v22, a[0:3] offset:0
    ds_write_b128 v22, a[4:7] offset:4224
    ds_write_b128 v22, a[8:11] offset:256
    ds_write_b128 v22, a[12:15] offset:4480
    ds_write_b128 v22, a[16:19] offset:512
    ds_write_b128 v22, a[20:23] offset:4736
    ds_write_b128 v22, a[24:27] offset:768
    ds_write_b128 v22, a[28:31] offset:4992
    v_mov_b32 v17, 12
    ds_write_b32 v16, v17
L_k_poll_thr14:
    ds_read_b128 v[8:11], v0 offset:32
    s_waitcnt lgkmcnt(0)
    v_min3_u32 v8, v8, v9, v10
    v_min_u32 v8, v8, v11
    v_cmp_gt_u32 vcc, 8, v8
    s_cbranch_vccz L_k_pok_thr14
    s_sleep 2
    s_sub_u32 s80, s80, 1
    s_cbranch_scc0 L_k_poll_thr14
    s_endpgm
L_k_pok_thr14:
    s_waitcnt vmcnt(16)
    s_mov_b32 s62, 0x1c000
    buffer_load_dwordx4 v[88:91], v20, s[8:11], s62 offen offset:0 nt
    buffer_load_dwordx4 v[92:95], v20, s[8:11], s62 offen offset:1024 nt
    buffer_load_dwordx4 v[96:99], v20, s[8:11], s62 offen offset:2048 nt
    buffer_load_dwordx4 v[100:103], v20, s[8:11], s62 offen offset:3072 nt
    s_mov_b32 s62, 0x1d000
    buffer_load_dwordx4 v[104:107], v20, s[8:11], s62 offen offset:0 nt
    buffer_load_dwordx4 v[108:111], v20, s[8:11], s62 offen offset:1024 nt
    buffer_load_dwordx4 v[112:115], v20, s[8:11], s62 offen offset:2048 nt
    buffer_load_dwordx4 v[116:119], v20, s[8:11], s62 offen offset:3072 nt
L_k_poll_fwk12:
    ds_read_b128 v[8:11], v0 offset:32
    ds_read_b64 v[12:13], v0 offset:48
    s_waitcnt lgkmcnt(0)
    v_min3_u32 v8, v8, v9, v10
    v_min3_u32 v8, v8, v11, v12
    v_min_u32 v8, v8, v13
    v_cmp_gt_u32 vcc, 4, v8
    s_cbranch_vccz L_k_pok_fwk12
    s_sleep 4
    s_sub_u32 s80, s80, 1
    s_cbranch_scc0 L_k_poll_fwk12
    s_endpgm
L_k_pok_fwk12:
    v_add_u32 v22, 0xc600, v21
    ds_write_b128 v22, v[24:27] offset:0
    ds_write_b128 v22, v[28:31] offset:4224
    ds_write_b128 v22, v[32:35] offset:256
    ds_write_b128 v22, v[36:39] offset:4480
    ds_write_b128 v22, v[40:43] offset:512
    ds_write_b128 v22, v[44:47] offset:4736
    ds_write_b128 v22, v[48:51] offset:768
    ds_write_b128 v22, v[52:55] offset:4992
    v_mov_b32 v17, 13
    ds_write_b32 v16, v17
L_k_poll_thr15:
    ds_read_b128 v[8:11], v0 offset:32
    s_waitcnt lgkmcnt(0)
    v_min3_u32 v8, v8, v9, v10
    v_min_u32 v8, v8, v11
    v_cmp_gt_u32 vcc, 9, v8
    s_cbranch_vccz L_k_pok_thr15
    s_sleep 2
    s_sub_u32 s80, s80, 1
    s_cbranch_scc0 L_k_poll_thr15
    s_endpgm
L_k_pok_thr15:
    s_waitcnt vmcnt(16)
    s_mov_b32 s62, 0x1c000
    buffer_load_dwordx4 v[120:123], v20, s[12:15], s62 offen offset:0 nt
    buffer_load_dwordx4 v[124:127], v20, s[12:15], s62 offen offset:1024 nt
    buffer_load_dwordx4 v[128:131], v20, s[12:15], s62 offen offset:2048 nt
    buffer_load_dwordx4 v[132:135], v20, s[12:15], s62 offen offset:3072 nt
    s_mov_b32 s62, 0x1d000
    buffer_load_dwordx4 v[136:139], v20, s[12:15], s62 offen offset:0 nt
    buffer_load_dwordx4 v[140:143], v20, s[12:15], s62 offen offset:1024 nt
    buffer_load_dwordx4 v[144:147], v20, s[12:15], s62 offen offset:2048 nt
    buffer_load_dwordx4 v[148:151], v20, s[12:15], s62 offen offset:3072 nt
L_k_poll_fwk13:
    ds_read_b128 v[8:11], v0 offset:32
    ds_read_b64 v[12:13], v0 offset:48
    s_waitcnt lgkmcnt(0)
    v_min3_u32 v8, v8, v9, v10
    v_min3_u32 v8, v8, v11, v12
    v_min_u32 v8, v8, v13
    v_cmp_gt_u32 vcc, 5, v8
    s_cbranch_vccz L_k_pok_fwk13
    s_sleep 4
    s_sub_u32 s80, s80, 1
    s_cbranch_scc0 L_k_poll_fwk13
    s_endpgm
L_k_pok_fwk13:
    v_add_u32 v22, 0x10800, v21
    s_waitcnt vmcnt(23)
    ds_write_b128 v22, v[56:59] offset:0
    s_waitcnt vmcnt(22)
    ds_write_b128 v22, v[60:63] offset:4224
    s_waitcnt vmcnt(21)
    ds_write_b128 v22, v[64:67] offset:256
    s_waitcnt vmcnt(20)
    ds_write_b128 v22, v[68:71] offset:4480
    s_waitcnt vmcnt(19)
    ds_write_b128 v22, v[72:75] offset:512
    s_waitcnt vmcnt(18)
    ds_write_b128 v22, v[76:79] offset:4736
    s_waitcnt vmcnt(17)
    ds_write_b128 v22, v[80:83] offset:768
    s_waitcnt vmcnt(16)
    ds_write_b128 v22, v[84:87] offset:4992
    v_mov_b32 v17, 14
    ds_write_b32 v16, v17
L_k_poll_fwk14:
    ds_read_b128 v[8:11], v0 offset:32
    ds_read_b64 v[12:13], v0 offset:48
    s_waitcnt lgkmcnt(0)
    v_min3_u32 v8, v8, v9, v10
    v_min3_u32 v8, v8, v11, v12
    v_min_u32 v8, v8, v13
    v_cmp_gt_u32 vcc, 6, v8
    s_cbranch_vccz L_k_pok_fwk14
    s_sleep 4
    s_sub_u32 s80, s80, 1
    s_cbranch_scc0 L_k_poll_fwk14
    s_endpgm
L_k_pok_fwk14:
    v_add_u32 v22, 0x14a00, v21
    s_waitcnt vmcnt(15)
    ds_write_b128 v22, v[88:91] offset:0
    s_waitcnt vmcnt(14)
    ds_write_b128 v22, v[92:95] offset:4224
    s_waitcnt vmcnt(13)
    ds_write_b128 v22, v[96:99] offset:256
    s_waitcnt vmcnt(12)
    ds_write_b128 v22, v[100:103] offset:4480
    s_waitcnt vmcnt(11)
    ds_write_b128 v22, v[104:107] offset:512
    s_waitcnt vmcnt(10)
    ds_write_b128 v22, v[108:111] offset:4736
    s_waitcnt vmcnt(9)
    ds_write_b128 v22, v[112:115] offset:768
    s_waitcnt vmcnt(8)
    ds_write_b128 v22, v[116:119] offset:4992
    v_mov_b32 v17, 15
    ds_write_b32 v16, v17
L_k_poll_fwk15:
    ds_read_b128 v[8:11], v0 offset:32
    ds_read_b64 v[12:13], v0 offset:48
    s_waitcnt lgkmcnt(0)
    v_min3_u32 v8, v8, v9, v10
    v_min3_u32 v8, v8, v11, v12
    v_min_u32 v8, v8, v13
    v_cmp_gt_u32 vcc, 7, v8
    s_cbranch_vccz L_k_pok_fwk15
    s_sleep 4
    s_sub_u32 s80, s80, 1
    s_cbranch_scc0 L_k_poll_fwk15
    s_endpgm
L_k_pok_fwk15:
    v_add_u32 v22, 0x18c00, v21
    s_waitcnt vmcnt(7)
    ds_write_b128 v22, v[120:123] offset:0
    s_waitcnt vmcnt(6)
    ds_write_b128 v22, v[124:127] offset:4224
    s_waitcnt vmcnt(5)
    ds_write_b128 v22, v[128:131] offset:256
    s_waitcnt vmcnt(4)
    ds_write_b128 v22, v[132:135] offset:4480
    s_waitcnt vmcnt(3)
    ds_write_b128 v22, v[136:139] offset:512
    s_waitcnt vmcnt(2)
    ds_write_b128 v22, v[140:143] offset:4736
    s_waitcnt vmcnt(1)
    ds_write_b128 v22, v[144:147] offset:768
    s_waitcnt vmcnt(0)
    ds_write_b128 v22, v[148:151] offset:4992
    v_mov_b32 v17, 16
    ds_write_b32 v16, v17
    s_lshl_b32 s47, s76, 2
    s_add_u32 s47, s47, 0x262d0
    v_mov_b32 v16, s47
    s_cmp_eq_u32 s76, 0
    s_cselect_b32 s52, 8, 10
    s_cselect_b32 s49, 7, 8
    s_mul_i32 s61, s49, 0x4200
L_k_poll_wf0:
    ds_read_b128 v[8:11], v0 offset:32
    ds_read_b64 v[12:13], v0 offset:48
    s_waitcnt lgkmcnt(0)
    v_min3_u32 v8, v8, v9, v10
    v_min3_u32 v8, v8, v11, v12
    v_min_u32 v8, v8, v13
    v_cmp_gt_u32 vcc, s52, v8
    s_cbranch_vccz L_k_pok_wf0
    s_sleep 4
    s_sub_u32 s80, s80, 1
    s_cbranch_scc0 L_k_poll_wf0
    s_endpgm
L_k_pok_wf0:
    s_add_u32 s48, s81, s76
    s_add_u32 s48, s48, 0
    s_and_b32 s48, s48, 7
    s_lshl_b32 s48, s48, 17
    s_add_u32 m0, s61, 0
    s_add_u32 s62, s48, 0
    buffer_load_dwordx4 v212, s[64:67], s62 offen offset:0 lds
    buffer_load_dwordx4 v213, s[64:67], s62 offen offset:1056 lds
    buffer_load_dwordx4 v214, s[64:67], s62 offen offset:2112 lds
    buffer_load_dwordx4 v215, s[64:67], s62 offen offset:3168 lds
    s_add_u32 m0, s61, 0x1080
    s_add_u32 s62, s48, 0x8000
    buffer_load_dwordx4 v212, s[64:67], s62 offen offset:0 lds
    buffer_load_dwordx4 v213, s[64:67], s62 offen offset:1056 lds
    buffer_load_dwordx4 v214, s[64:67], s62 offen offset:2112 lds
    buffer_load_dwordx4 v215, s[64:67], s62 offen offset:3168 lds
    s_add_u32 m0, s61, 0x2100
    s_add_u32 s62, s48, 0x10000
    buffer_load_dwordx4 v212, s[64:67], s62 offen offset:0 lds
    buffer_load_dwordx4 v213, s[64:67], s62 offen offset:1056 lds
    buffer_load_dwordx4 v214, s[64:67], s62 offen offset:2112 lds
    buffer_load_dwordx4 v215, s[64:67], s62 offen offset:3168 lds
    s_add_u32 m0, s61, 0x3180
    s_add_u32 s62, s48, 0x18000
    buffer_load_dwordx4 v212, s[64:67], s62 offen offset:0 lds
    buffer_load_dwordx4 v213, s[64:67], s62 offen offset:1056 lds
    buffer_load_dwordx4 v214, s[64:67], s62 offen offset:2112 lds
    buffer_load_dwordx4 v215, s[64:67], s62 offen offset:3168 lds
    s_cmp_eq_u32 s76, 0
    s_cselect_b32 s52, 10, 12
    s_cselect_b32 s49, 0, 1
    s_mul_i32 s61, s49, 0x4200
    s_waitcnt vmcnt(0)
    v_mov_b32 v17, 1
    ds_write_b32 v16, v17
L_k_poll_wf1:
    ds_read_b128 v[8:11], v0 offset:32
    ds_read_b64 v[12:13], v0 offset:48
    s_waitcnt lgkmcnt(0)
    v_min3_u32 v8, v8, v9, v10
    v_min3_u32 v8, v8, v11, v12
    v_min_u32 v8, v8, v13
    v_cmp_gt_u32 vcc, s52, v8
    s_cbranch_vccz L_k_pok_wf1
    s_sleep 4
    s_sub_u32 s80, s80, 1
    s_cbranch_scc0 L_k_poll_wf1
    s_endpgm
L_k_pok_wf1:
    s_add_u32 s48, s81, s76
    s_add_u32 s48, s48, 2
    s_and_b32 s48, s48, 7
    s_lshl_b32 s48, s48, 17
    s_add_u32 m0, s61, 0
    s_add_u32 s62, s48, 0
    buffer_load_dwordx4 v212, s[64:67], s62 offen offset:0 lds
    buffer_load_dwordx4 v213, s[64:67], s62 offen offset:1056 lds
    buffer_load_dwordx4 v214, s[64:67], s62 offen offset:2112 lds
    buffer_load_dwordx4 v215, s[64:67], s62 offen offset:3168 lds
    s_add_u32 m0, s61, 0x1080
    s_add_u32 s62, s48, 0x8000
    buffer_load_dwordx4 v212, s[64:67], s62 offen offset:0 lds
    buffer_load_dwordx4 v213, s[64:67], s62 offen offset:1056 lds
    buffer_load_dwordx4 v214, s[64:67], s62 offen offset:2112 lds
    buffer_load_dwordx4 v215, s[64:67], s62 offen offset:3168 lds
    s_add_u32 m0, s61, 0x2100
    s_add_u32 s62, s48, 0x10000
    buffer_load_dwordx4 v212, s[64:67], s62 offen offset:0 lds
    buffer_load_dwordx4 v213, s[64:67], s62 offen offset:1056 lds
    buffer_load_dwordx4 v214, s[64:67], s62 offen offset:2112 lds
    buffer_load_dwordx4 v215, s[64:67], s62 offen offset:3168 lds
    s_add_u32 m0, s61, 0x3180
    s_add_u32 s62, s48, 0x18000
    buffer_load_dwordx4 v212, s[64:67], s62 offen offset:0 lds
    buffer_load_dwordx4 v213, s[64:67], s62 offen offset:1056 lds
    buffer_load_dwordx4 v214, s[64:67], s62 offen offset:2112 lds
    buffer_load_dwordx4 v215, s[64:67], s62 offen offset:3168 lds
    s_cmp_eq_u32 s76, 0
    s_cselect_b32 s52, 12, 14
    s_cselect_b32 s49, 2, 3
    s_mul_i32 s61, s49, 0x4200
    s_waitcnt vmcnt(0)
    v_mov_b32 v17, 2
    ds_write_b32 v16, v17
L_k_poll_wf2:
    ds_read_b128 v[8:11], v0 offset:32
    ds_read_b64 v[12:13], v0 offset:48
    s_waitcnt lgkmcnt(0)
    v_min3_u32 v8, v8, v9, v10
    v_min3_u32 v8, v8, v11, v12
    v_min_u32 v8, v8, v13
    v_cmp_gt_u32 vcc, s52, v8
    s_cbranch_vccz L_k_pok_wf2
    s_sleep 4
    s_sub_u32 s80, s80, 1
    s_cbranch_scc0 L_k_poll_wf2
    s_endpgm
L_k_pok_wf2:
    s_add_u32 s48, s81, s76
    s_add_u32 s48, s48, 4
    s_and_b32 s48, s48, 7
    s_lshl_b32 s48, s48, 17
    s_add_u32 m0, s61, 0
    s_add_u32 s62, s48, 0
    buffer_load_dwordx4 v212, s[64:67], s62 offen offset:0 lds
    buffer_load_dwordx4 v213, s[64:67], s62 offen offset:1056 lds
    buffer_load_dwordx4 v214, s[64:67], s62 offen offset:2112 lds
    buffer_load_dwordx4 v215, s[64:67], s62 offen offset:3168 lds
    s_add_u32 m0, s61, 0x1080
    s_add_u32 s62, s48, 0x8000
    buffer_load_dwordx4 v212, s[64:67], s62 offen offset:0 lds
    buffer_load_dwordx4 v213, s[64:67], s62 offen offset:1056 lds
    buffer_load_dwordx4 v214, s[64:67], s62 offen offset:2112 lds
    buffer_load_dwordx4 v215, s[64:67], s62 offen offset:3168 lds
    s_add_u32 m0, s61, 0x2100
    s_add_u32 s62, s48, 0x10000
    buffer_load_dwordx4 v212, s[64:67], s62 offen offset:0 lds
    buffer_load_dwordx4 v213, s[64:67], s62 offen offset:1056 lds
    buffer_load_dwordx4 v214, s[64:67], s62 offen offset:2112 lds
    buffer_load_dwordx4 v215, s[64:67], s62 offen offset:3168 lds
    s_add_u32 m0, s61, 0x3180
    s_add_u32 s62, s48, 0x18000
    buffer_load_dwordx4 v212, s[64:67], s62 offen offset:0 lds
    buffer_load_dwordx4 v213, s[64:67], s62 offen offset:1056 lds
    buffer_load_dwordx4 v214, s[64:67], s62 offen offset:2112 lds
    buffer_load_dwordx4 v215, s[64:67], s62 offen offset:3168 lds
    s_cmp_eq_u32 s76, 0
    s_cselect_b32 s52, 14, 16
    s_cselect_b32 s49, 4, 5
    s_mul_i32 s61, s49, 0x4200
    s_waitcnt vmcnt(0)
    v_mov_b32 v17, 3
    ds_write_b32 v16, v17
L_k_poll_wf3:
    ds_read_b128 v[8:11], v0 offset:32
    ds_read_b64 v[12:13], v0 offset:48
    s_waitcnt lgkmcnt(0)
    v_min3_u32 v8, v8, v9, v10
    v_min3_u32 v8, v8, v11, v12
    v_min_u32 v8, v8, v13
    v_cmp_gt_u32 vcc, s52, v8
    s_cbranch_vccz L_k_pok_wf3
    s_sleep 1
    s_sub_u32 s80, s80, 1
    s_cbranch_scc0 L_k_poll_wf3
    s_endpgm
L_k_pok_wf3:
    s_add_u32 s48, s81, s76
    s_add_u32 s48, s48, 6
    s_and_b32 s48, s48, 7
    s_lshl_b32 s48, s48, 17
    s_add_u32 m0, s61, 0
    s_add_u32 s62, s48, 0
    buffer_load_dwordx4 v212, s[64:67], s62 offen offset:0 lds
    buffer_load_dwordx4 v213, s[64:67], s62 offen offset:1056 lds
    buffer_load_dwordx4 v214, s[64:67], s62 offen offset:2112 lds
    buffer_load_dwordx4 v215, s[64:67], s62 offen offset:3168 lds
    s_add_u32 m0, s61, 0x1080
    s_add_u32 s62, s48, 0x8000
    buffer_load_dwordx4 v212, s[64:67], s62 offen offset:0 lds
    buffer_load_dwordx4 v213, s[64:67], s62 offen offset:1056 lds
    buffer_load_dwordx4 v214, s[64:67], s62 offen offset:2112 lds
    buffer_load_dwordx4 v215, s[64:67], s62 offen offset:3168 lds
    s_add_u32 m0, s61, 0x2100
    s_add_u32 s62, s48, 0x10000
    buffer_load_dwordx4 v212, s[64:67], s62 offen offset:0 lds
    buffer_load_dwordx4 v213, s[64:67], s62 offen offset:1056 lds
    buffer_load_dwordx4 v214, s[64:67], s62 offen offset:2112 lds
    buffer_load_dwordx4 v215, s[64:67], s62 offen offset:3168 lds
    s_add_u32 m0, s61, 0x3180
    s_add_u32 s62, s48, 0x18000
    buffer_load_dwordx4 v212, s[64:67], s62 offen offset:0 lds
    buffer_load_dwordx4 v213, s[64:67], s62 offen offset:1056 lds
    buffer_load_dwordx4 v214, s[64:67], s62 offen offset:2112 lds
    buffer_load_dwordx4 v215, s[64:67], s62 offen offset:3168 lds
    s_waitcnt vmcnt(0)
    v_mov_b32 v17, 4
    ds_write_b32 v16, v17
L_k_h_p3:
    v_and_b32 v5, 3, v1
    v_lshlrev_b32 v5, 3, v5
    v_bfe_u32 v6, v1, 3, 2
    v_mul_u32_u24 v6, 0x420, v6
    v_add_u32 v5, v5, v6
    v_bfe_u32 v6, v1, 2, 1
    v_lshl_add_u32 v5, v6, 7, v5
    v_bfe_u32 v6, v1, 5, 1
    v_lshl_add_u32 v2, v6, 8, v5
    v_lshlrev_b32 v3, 4, v1
    s_lshl_b32 s47, s60, 1
    s_add_u32 s47, s47, 0
L_k_poll_hown:
    ds_read_b32 v8, v0 offset:96
    s_waitcnt lgkmcnt(0)
    v_cmp_gt_u32 vcc, 6, v8
    s_cbranch_vccz L_k_pok_hown
    s_sleep 1
    s_sub_u32 s80, s80, 1
    s_cbranch_scc0 L_k_poll_hown
    s_endpgm
L_k_pok_hown:
L_k_poll_ho0:
    ds_read_b32 v8, v0 offset:112
    s_waitcnt lgkmcnt(0)
    v_cmp_gt_u32 vcc, s47, v8
    s_cbranch_vccz L_k_pok_ho0
    s_sleep 1
    s_sub_u32 s80, s80, 1
    s_cbranch_scc0 L_k_poll_ho0
    s_endpgm
L_k_pok_ho0:
    s_add_u32 s48, s81, s47
    s_and_b32 s48, s48, 7
    s_lshl_b32 s48, s48, 12
    s_add_u32 s62, s48, 0x180000
    buffer_load_dwordx4 v[40:43], v3, s[16:19], s62 offen offset:0
    buffer_load_dwordx4 v[44:47], v3, s[16:19], s62 offen offset:1024
    buffer_load_dwordx4 v[48:51], v3, s[16:19], s62 offen offset:2048
    buffer_load_dwordx4 v[52:55], v3, s[16:19], s62 offen offset:3072
    s_lshl_b32 s47, s60, 1
    s_add_u32 s47, s47, 1
L_k_poll_ho1:
    ds_read_b32 v8, v0 offset:112
    s_waitcnt lgkmcnt(0)
    v_cmp_gt_u32 vcc, s47, v8
    s_cbranch_vccz L_k_pok_ho1
    s_sleep 1
    s_sub_u32 s80, s80, 1
    s_cbranch_scc0 L_k_poll_ho1
    s_endpgm
L_k_pok_ho1:
    s_add_u32 s48, s81, s47
    s_and_b32 s48, s48, 7
    s_lshl_b32 s48, s48, 12
    s_add_u32 s62, s48, 0x180000
    buffer_load_dwordx4 v[56:59], v3, s[16:19], s62 offen offset:0
    buffer_load_dwordx4 v[60:63], v3, s[16:19], s62 offen offset:1024
    buffer_load_dwordx4 v[64:67], v3, s[16:19], s62 offen offset:2048
    buffer_load_dwordx4 v[68:71], v3, s[16:19], s62 offen offset:3072
    s_add_u32 s49, s60, 1
L_k_poll_hwo0:
    ds_read_b32 v8, v0 offset:80
    s_waitcnt lgkmcnt(0)
    v_cmp_gt_u32 vcc, s49, v8
    s_cbranch_vccz L_k_pok_hwo0
    s_sleep 1
    s_sub_u32 s80, s80, 1
    s_cbranch_scc0 L_k_poll_hwo0
    s_endpgm
L_k_pok_hwo0:
    s_lshl_b32 s47, s60, 1
    s_add_u32 s47, s47, 7
    s_cmp_ge_u32 s47, 9
    s_cselect_b32 s48, 9, 0
    s_sub_u32 s47, s47, s48
    s_mul_i32 s47, s47, 0x4200
    v_add_u32 v5, s47, v2
    ds_read_b64_tr_b16 v[72:73], v5 offset:0
    ds_read_b64_tr_b16 v[74:75], v5 offset:512
    ds_read_b64_tr_b16 v[76:77], v5 offset:32
    ds_read_b64_tr_b16 v[78:79], v5 offset:544
    ds_read_b64_tr_b16 v[80:81], v5 offset:64
    ds_read_b64_tr_b16 v[82:83], v5 offset:576
    ds_read_b64_tr_b16 v[84:85], v5 offset:96
    ds_read_b64_tr_b16 v[86:87], v5 offset:608
    ds_read_b64_tr_b16 v[88:89], v5 offset:4224
    ds_read_b64_tr_b16 v[90:91], v5 offset:4736
    ds_read_b64_tr_b16 v[92:93], v5 offset:4256
    ds_read_b64_tr_b16 v[94:95], v5 offset:4768
    ds_read_b64_tr_b16 v[96:97], v5 offset:4288
    ds_read_b64_tr_b16 v[98:99], v5 offset:4800
    ds_read_b64_tr_b16 v[100:101], v5 offset:4320
    ds_read_b64_tr_b16 v[102:103], v5 offset:4832
    ds_read_b64_tr_b16 v[104:105], v5 offset:8448
    ds_read_b64_tr_b16 v[106:107], v5 offset:8960
    ds_read_b64_tr_b16 v[108:109], v5 offset:8480
    ds_read_b64_tr_b16 v[110:111], v5 offset:8992
    ds_read_b64_tr_b16 v[112:113], v5 offset:8512
    ds_read_b64_tr_b16 v[114:115], v5 offset:9024
    ds_read_b64_tr_b16 v[116:117], v5 offset:8544
    ds_read_b64_tr_b16 v[118:119], v5 offset:9056
    ds_read_b64_tr_b16 v[120:121], v5 offset:12672
    ds_read_b64_tr_b16 v[122:123], v5 offset:13184
    ds_read_b64_tr_b16 v[124:125], v5 offset:12704
    ds_read_b64_tr_b16 v[126:127], v5 offset:13216
    ds_read_b64_tr_b16 v[128:129], v5 offset:12736
    ds_read_b64_tr_b16 v[130:131], v5 offset:13248
    ds_read_b64_tr_b16 v[132:133], v5 offset:12768
    ds_read_b64_tr_b16 v[134:135], v5 offset:13280
    s_waitcnt vmcnt(7) lgkmcnt(15)
    v_mfma_f32_16x16x32_bf16 v[24:27], v[72:75], v[40:43], 0
    v_mfma_f32_16x16x32_bf16 v[28:31], v[76:79], v[40:43], 0
    v_mfma_f32_16x16x32_bf16 v[32:35], v[80:83], v[40:43], 0
    v_mfma_f32_16x16x32_bf16 v[36:39], v[84:87], v[40:43], 0
    s_waitcnt vmcnt(6)
    v_mfma_f32_16x16x32_bf16 v[24:27], v[88:91], v[44:47], v[24:27]
    v_mfma_f32_16x16x32_bf16 v[28:31], v[92:95], v[44:47], v[28:31]
    v_mfma_f32_16x16x32_bf16 v[32:35], v[96:99], v[44:47], v[32:35]
    v_mfma_f32_16x16x32_bf16 v[36:39], v[100:103], v[44:47], v[36:39]
    s_waitcnt vmcnt(5) lgkmcnt(14)
    v_mfma_f32_16x16x32_bf16 v[24:27], v[104:107], v[48:51], v[24:27]
    s_waitcnt lgkmcnt(12)
    v_mfma_f32_16x16x32_bf16 v[28:31], v[108:111], v[48:51], v[28:31]
    s_waitcnt lgkmcnt(10)
    v_mfma_f32_16x16x32_bf16 v[32:35], v[112:115], v[48:51], v[32:35]
    s_waitcnt lgkmcnt(8)
    v_mfma_f32_16x16x32_bf16 v[36:39], v[116:119], v[48:51], v[36:39]
    s_waitcnt vmcnt(4) lgkmcnt(6)
    v_mfma_f32_16x16x32_bf16 v[24:27], v[120:123], v[52:55], v[24:27]
    s_waitcnt lgkmcnt(4)
    v_mfma_f32_16x16x32_bf16 v[28:31], v[124:127], v[52:55], v[28:31]
    s_waitcnt lgkmcnt(2)
    v_mfma_f32_16x16x32_bf16 v[32:35], v[128:131], v[52:55], v[32:35]
    s_waitcnt lgkmcnt(0)
    v_mfma_f32_16x16x32_bf16 v[36:39], v[132:135], v[52:55], v[36:39]
    s_add_u32 s49, s60, 1
L_k_poll_hwo1:
    ds_read_b32 v8, v0 offset:84
    s_waitcnt lgkmcnt(0)
    v_cmp_gt_u32 vcc, s49, v8
    s_cbranch_vccz L_k_pok_hwo1
    s_sleep 1
    s_sub_u32 s80, s80, 1
    s_cbranch_scc0 L_k_poll_hwo1
    s_endpgm
L_k_pok_hwo1:
    s_lshl_b32 s47, s60, 1
    s_add_u32 s47, s47, 8
    s_cmp_ge_u32 s47, 9
    s_cselect_b32 s48, 9, 0
    s_sub_u32 s47, s47, s48
    s_mul_i32 s47, s47, 0x4200
    v_add_u32 v5, s47, v2
    ds_read_b64_tr_b16 v[72:73], v5 offset:0
    ds_read_b64_tr_b16 v[74:75], v5 offset:512
    ds_read_b64_tr_b16 v[76:77], v5 offset:32
    ds_read_b64_tr_b16 v[78:79], v5 offset:544
    ds_read_b64_tr_b16 v[80:81], v5 offset:64
    ds_read_b64_tr_b16 v[82:83], v5 offset:576
    ds_read_b64_tr_b16 v[84:85], v5 offset:96
    ds_read_b64_tr_b16 v[86:87], v5 offset:608
    ds_read_b64_tr_b16 v[88:89], v5 offset:4224
    ds_read_b64_tr_b16 v[90:91], v5 offset:4736
    ds_read_b64_tr_b16 v[92:93], v5 offset:4256
    ds_read_b64_tr_b16 v[94:95], v5 offset:4768
    ds_read_b64_tr_b16 v[96:97], v5 offset:4288
    ds_read_b64_tr_b16 v[98:99], v5 offset:4800
    ds_read_b64_tr_b16 v[100:101], v5 offset:4320
    ds_read_b64_tr_b16 v[102:103], v5 offset:4832
    ds_read_b64_tr_b16 v[104:105], v5 offset:8448
    ds_read_b64_tr_b16 v[106:107], v5 offset:8960
    ds_read_b64_tr_b16 v[108:109], v5 offset:8480
    ds_read_b64_tr_b16 v[110:111], v5 offset:8992
    ds_read_b64_tr_b16 v[112:113], v5 offset:8512
    ds_read_b64_tr_b16 v[114:115], v5 offset:9024
    ds_read_b64_tr_b16 v[116:117], v5 offset:8544
    ds_read_b64_tr_b16 v[118:119], v5 offset:9056
    ds_read_b64_tr_b16 v[120:121], v5 offset:12672
    ds_read_b64_tr_b16 v[122:123], v5 offset:13184
    ds_read_b64_tr_b16 v[124:125], v5 offset:12704
    ds_read_b64_tr_b16 v[126:127], v5 offset:13216
    ds_read_b64_tr_b16 v[128:129], v5 offset:12736
    ds_read_b64_tr_b16 v[130:131], v5 offset:13248
    ds_read_b64_tr_b16 v[132:133], v5 offset:12768
    ds_read_b64_tr_b16 v[134:135], v5 offset:13280
    s_waitcnt vmcnt(3) lgkmcnt(15)
    v_mfma_f32_16x16x32_bf16 v[24:27], v[72:75], v[56:59], v[24:27]
    v_mfma_f32_16x16x32_bf16 v[28:31], v[76:79], v[56:59], v[28:31]
    v_mfma_f32_16x16x32_bf16 v[32:35], v[80:83], v[56:59], v[32:35]
    v_mfma_f32_16x16x32_bf16 v[36:39], v[84:87], v[56:59], v[36:39]
    s_waitcnt vmcnt(2)
    v_mfma_f32_16x16x32_bf16 v[24:27], v[88:91], v[60:63], v[24:27]
    v_mfma_f32_16x16x32_bf16 v[28:31], v[92:95], v[60:63], v[28:31]
    v_mfma_f32_16x16x32_bf16 v[32:35], v[96:99], v[60:63], v[32:35]
    v_mfma_f32_16x16x32_bf16 v[36:39], v[100:103], v[60:63], v[36:39]
    s_waitcnt vmcnt(1) lgkmcnt(14)
    v_mfma_f32_16x16x32_bf16 v[24:27], v[104:107], v[64:67], v[24:27]
    s_waitcnt lgkmcnt(12)
    v_mfma_f32_16x16x32_bf16 v[28:31], v[108:111], v[64:67], v[28:31]
    s_waitcnt lgkmcnt(10)
    v_mfma_f32_16x16x32_bf16 v[32:35], v[112:115], v[64:67], v[32:35]
    s_waitcnt lgkmcnt(8)
    v_mfma_f32_16x16x32_bf16 v[36:39], v[116:119], v[64:67], v[36:39]
    s_waitcnt vmcnt(0) lgkmcnt(6)
    v_mfma_f32_16x16x32_bf16 v[24:27], v[120:123], v[68:71], v[24:27]
    s_waitcnt lgkmcnt(4)
    v_mfma_f32_16x16x32_bf16 v[28:31], v[124:127], v[68:71], v[28:31]
    s_waitcnt lgkmcnt(2)
    v_mfma_f32_16x16x32_bf16 v[32:35], v[128:131], v[68:71], v[32:35]
    s_waitcnt lgkmcnt(0)
    v_mfma_f32_16x16x32_bf16 v[36:39], v[132:135], v[68:71], v[36:39]
    s_lshl_b32 s47, s60, 12
    s_add_u32 s47, s47, 0x18c00
    v_add_u32 v5, s47, v3
    ds_write_b128 v5, v[24:27] offset:0
    ds_write_b128 v5, v[28:31] offset:1024
    s_nop 0
    ds_write_b128 v5, v[32:35] offset:2048
    s_nop 0
    ds_write_b128 v5, v[36:39] offset:3072
    v_mov_b32 v6, 1
    s_mov_b64 exec, 1
    ds_add_u32 v0, v6 offset:104
    s_mov_b64 exec, -1
L_k_poll_hred:
    ds_read_b32 v8, v0 offset:104
    s_waitcnt lgkmcnt(0)
    v_cmp_gt_u32 vcc, 4, v8
    s_cbranch_vccz L_k_pok_hred
    s_sub_u32 s80, s80, 1
    s_cbranch_scc0 L_k_poll_hred
    s_endpgm
L_k_pok_hred:
    s_lshl_b32 s47, s60, 10
    s_add_u32 s47, s47, 0x18c00
    v_add_u32 v5, s47, v3
    ds_read_b128 v[72:75], v5 offset:0
    ds_read_b128 v[76:79], v5 offset:4096
    ds_read_b128 v[80:83], v5 offset:8192
    ds_read_b128 v[84:87], v5 offset:12288
    s_waitcnt lgkmcnt(2)
    v_add_f32 v72, v72, v76
    s_waitcnt lgkmcnt(0)
    v_add_f32 v80, v80, v84
    v_add_f32 v73, v73, v77
    v_add_f32 v81, v81, v85
    v_add_f32 v74, v74, v78
    v_add_f32 v82, v82, v86
    v_add_f32 v75, v75, v79
    v_add_f32 v83, v83, v87
    v_add_f32 v72, v72, v80
    v_add_f32 v73, v73, v81
    v_add_f32 v74, v74, v82
    v_add_f32 v75, v75, v83
    s_mul_i32 s47, s82, 0xd000
    s_lshl_b32 s48, s60, 10
    s_add_u32 s47, s47, s48
    s_add_u32 s47, s47, 0xc000
    buffer_store_dwordx4 v[72:75], v3, s[20:23], s47 offen sc1
    s_lshl_b32 s47, s82, 2
    s_add_u32 s49, s47, s84
    s_waitcnt vmcnt(0)
    v_mov_b32 v5, 1
    s_mov_b64 exec, 1
    ds_add_rtn_u32 v6, v0, v5 offset:100
    s_waitcnt lgkmcnt(0)
    v_cmp_eq_u32 vcc, 7, v6
    s_cbranch_vccz L_k_arr_h2
L_k_poll_nonceh2:
    ds_read_b32 v5, v0 offset:116
    s_waitcnt lgkmcnt(0)
    v_cmp_gt_u32 vcc, 1, v5
    s_cbranch_vccz L_k_pok_nonceh2
    s_sleep 1
    s_sub_u32 s80, s80, 1
    s_cbranch_scc0 L_k_poll_nonceh2
    s_endpgm
L_k_pok_nonceh2:
    v_mov_b32 v6, s49
    buffer_store_dword v5, v6, s[72:75], 0 offen sc1
L_k_arr_h2:
    s_mov_b64 exec, -1
    s_cmp_eq_u32 s60, 3
    s_cbranch_scc0 L_k_nowatch
L_k_poll_wn2:
    ds_read_b32 v7, v0 offset:116
    s_waitcnt lgkmcnt(0)
    v_cmp_gt_u32 vcc, 1, v7
    s_cbranch_vccz L_k_pok_wn2
    s_sleep 1
    s_sub_u32 s80, s80, 1
    s_cbranch_scc0 L_k_poll_wn2
    s_endpgm
L_k_pok_wn2:
    v_lshlrev_b32 v6, 2, v1
    v_add_u32 v6, s84, v6
    s_mov_b64 exec, 15
L_k_w2:
    buffer_load_dword v5, v6, s[72:75], 0 offen sc1
    s_waitcnt vmcnt(0)
    v_cmp_ne_u32 vcc, v5, v7
    s_cbranch_vccz L_k_w2ok
    s_sleep 2
    s_sub_u32 s80, s80, 1
    s_cbranch_scc0 L_k_w2
    s_endpgm
L_k_w2ok:
    s_mov_b64 exec, -1
    v_mov_b32 v5, 1
    ds_write_b32 v0, v5 offset:108
L_k_nowatch:
    v_lshlrev_b32 v5, 4, v1
    v_and_b32 v6, 15, v1
    v_lshlrev_b32 v6, 10, v6
    v_lshrrev_b32 v72, 4, v1
    v_lshl_add_u32 v6, v72, 3, v6
    s_mul_i32 s47, s82, 12
    s_add_u32 s47, s47, s44
    s_lshl_b32 s48, s47, 10
    s_add_u32 s49, s48, 0x2000
    s_cmp_lt_u32 s44, 4
    s_cselect_b32 s50, 1, 0
    s_cmp_eq_u32 s82, 3
    s_cselect_b32 s50, 1, s50
    s_cmp_eq_u32 s50, 1
    s_cselect_b32 s49, s49, 0x40000000
L_k_poll_goh:
    ds_read_b32 v72, v0 offset:108
    s_waitcnt lgkmcnt(0)
    v_cmp_gt_u32 vcc, 1, v72
    s_cbranch_vccz L_k_pok_goh
    s_sleep 1
    s_sub_u32 s80, s80, 1
    s_cbranch_scc0 L_k_poll_goh
    s_endpgm
L_k_pok_goh:
    s_add_u32 s62, s48, 0
    buffer_load_dwordx4 v[72:75], v5, s[20:23], s62 offen sc1
    s_add_u32 s62, s48, 0xd000
    buffer_load_dwordx4 v[76:79], v5, s[20:23], s62 offen sc1
    s_add_u32 s62, s48, 0x1a000
    buffer_load_dwordx4 v[80:83], v5, s[20:23], s62 offen sc1
    s_add_u32 s62, s48, 0x27000
    buffer_load_dwordx4 v[84:87], v5, s[20:23], s62 offen sc1
    s_add_u32 s62, s49, 0
    buffer_load_dwordx4 v[88:91], v5, s[20:23], s62 offen sc1
    s_add_u32 s62, s49, 0xd000
    buffer_load_dwordx4 v[92:95], v5, s[20:23], s62 offen sc1
    s_add_u32 s62, s49, 0x1a000
    buffer_load_dwordx4 v[96:99], v5, s[20:23], s62 offen sc1
    s_add_u32 s62, s49, 0x27000
    buffer_load_dwordx4 v[100:103], v5, s[20:23], s62 offen sc1
    s_waitcnt vmcnt(6)
    v_add_f32 v72, v72, v76
    s_waitcnt vmcnt(4)
    v_add_f32 v80, v80, v84
    v_add_f32 v73, v73, v77
    v_add_f32 v81, v81, v85
    v_add_f32 v74, v74, v78
    v_add_f32 v82, v82, v86
    v_add_f32 v75, v75, v79
    v_add_f32 v83, v83, v87
    v_add_f32 v72, v72, v80
    v_add_f32 v73, v73, v81
    v_add_f32 v74, v74, v82
    v_add_f32 v75, v75, v83
    v_cvt_pk_bf16_f32 v72, v72, v73
    v_cvt_pk_bf16_f32 v73, v74, v75
    s_lshr_b32 s48, s47, 2
    s_lshl_b32 s48, s48, 14
    s_and_b32 s62, s47, 3
    s_lshl_b32 s62, s62, 5
    s_add_u32 s62, s62, s48
    buffer_store_dwordx2 v[72:73], v6, s[24:27], s62 offen
    s_waitcnt vmcnt(3)
    v_add_f32 v88, v88, v92
    s_waitcnt vmcnt(1)
    v_add_f32 v96, v96, v100
    v_add_f32 v89, v89, v93
    v_add_f32 v97, v97, v101
    v_add_f32 v90, v90, v94
    v_add_f32 v98, v98, v102
    v_add_f32 v91, v91, v95
    v_add_f32 v99, v99, v103
    v_add_f32 v88, v88, v96
    v_add_f32 v89, v89, v97
    v_add_f32 v90, v90, v98
    v_add_f32 v91, v91, v99
    v_cvt_pk_bf16_f32 v88, v88, v89
    v_cvt_pk_bf16_f32 v89, v90, v91
    s_add_u32 s47, s47, 8
    s_lshr_b32 s48, s47, 2
    s_lshl_b32 s48, s48, 14
    s_and_b32 s62, s47, 3
    s_lshl_b32 s62, s62, 5
    s_add_u32 s62, s62, s48
    s_cmp_eq_u32 s50, 1
    s_cselect_b32 s62, s62, 0x40000000
    buffer_store_dwordx2 v[88:89], v6, s[24:27], s62 offen
    s_endpgm
L_k_end:
    s_endpgm
L_k_h_rare:
    s_nop 15
    v_mfma_f32_16x16x32_bf16 v[24:27], v[84:87], v[68:71], 0
    v_mfma_f32_16x16x32_bf16 v[24:27], v[88:91], v[72:75], v[24:27]
    v_mfma_f32_16x16x32_bf16 v[24:27], v[92:95], v[76:79], v[24:27]
    v_mfma_f32_16x16x32_bf16 v[24:27], v[96:99], v[80:83], v[24:27]
    v_mfma_f32_16x16x32_bf16 v[28:31], v[100:103], v[68:71], 0
    v_mfma_f32_16x16x32_bf16 v[28:31], v[104:107], v[72:75], v[28:31]
    v_mfma_f32_16x16x32_bf16 v[28:31], v[108:111], v[76:79], v[28:31]
    v_mfma_f32_16x16x32_bf16 v[28:31], v[112:115], v[80:83], v[28:31]
    s_nop 3
    v_max3_f32 v5, v24, v25, v26
    s_nop 2
    v_max3_f32 v5, v5, v27, v28
    v_max3_f32 v5, v5, v29, v30
    v_max_f32 v5, v5, v31
    v_mov_b32 v6, v5
    v_mov_b32 v7, v5
    s_nop 1
    v_permlane32_swap_b32 v6, v7
    v_max_f32 v5, v6, v7
    v_mov_b32 v6, v5
    v_mov_b32 v7, v5
    s_nop 1
    v_permlane16_swap_b32 v6, v7
    v_max_f32 v5, v6, v7
    v_add_f32 v5, 0x40e00000, v5
    v_max_f32_e64 v5, v5, -v20
    v_sub_f32_e64 v6, -v20, v5
    v_exp_f32 v6, v6
    v_sub_f32 v20, 0, v5
    v_sub_f32 v21, 0, v5
    v_sub_f32 v22, 0, v5
    v_sub_f32 v23, 0, v5
    v_mul_f32 v36, v36, v6
    v_mul_f32 v37, v37, v6
    v_mul_f32 v38, v38, v6
    v_mul_f32 v39, v39, v6
    v_mul_f32 v40, v40, v6
    v_mul_f32 v41, v41, v6
    v_mul_f32 v42, v42, v6
    v_mul_f32 v43, v43, v6
    v_mul_f32 v44, v44, v6
    v_mul_f32 v45, v45, v6
    v_mul_f32 v46, v46, v6
    v_mul_f32 v47, v47, v6
    v_mul_f32 v48, v48, v6
    v_mul_f32 v49, v49, v6
    v_mul_f32 v50, v50, v6
    v_mul_f32 v51, v51, v6
    v_mul_f32 v52, v52, v6
    v_mul_f32 v53, v53, v6
    v_mul_f32 v54, v54, v6
    v_mul_f32 v55, v55, v6
    v_mul_f32 v56, v56, v6
    v_mul_f32 v57, v57, v6
    v_mul_f32 v58, v58, v6
    v_mul_f32 v59, v59, v6
    v_mul_f32 v60, v60, v6
    v_mul_f32 v61, v61, v6
    v_mul_f32 v62, v62, v6
    v_mul_f32 v63, v63, v6
    v_mul_f32 v64, v64, v6
    v_mul_f32 v65, v65, v6
    v_mul_f32 v66, v66, v6
    v_mul_f32 v67, v67, v6
    v_mul_f32 v32, v32, v6
    v_mul_f32 v33, v33, v6
    v_mul_f32 v34, v34, v6
    v_mul_f32 v35, v35, v6
    v_add_f32 v24, v24, v20
    v_add_f32 v25, v25, v20
    v_add_f32 v26, v26, v20
    v_add_f32 v27, v27, v20
    v_add_f32 v28, v28, v20
    v_add_f32 v29, v29, v20
    v_add_f32 v30, v30, v20
    v_add_f32 v31, v31, v20
    v_exp_f32 v24, v24
    v_exp_f32 v25, v25
    v_exp_f32 v26, v26
    v_exp_f32 v27, v27
    v_exp_f32 v28, v28
    v_exp_f32 v29, v29
    v_exp_f32 v30, v30
    v_exp_f32 v31, v31
    v_cvt_pk_bf16_f32 v24, v24, v25
    v_cvt_pk_bf16_f32 v25, v26, v27
    v_cvt_pk_bf16_f32 v26, v28, v29
    v_cvt_pk_bf16_f32 v27, v30, v31
    s_nop 3
    s_branch L_k_h_ret
L_k_c_rare0:
    s_waitcnt lgkmcnt(0)
    s_nop 15
    ds_read_b128 a[16:19], v2 offset:0
    ds_read_b128 a[20:23], v2 offset:64
    ds_read_b128 a[24:27], v2 offset:128
    ds_read_b128 a[28:31], v2 offset:192
    s_waitcnt lgkmcnt(3)
    v_mfma_f32_16x16x32_bf16 v[20:23], a[16:19], v[168:171], 0
    v_mfma_f32_16x16x32_bf16 v[24:27], a[16:19], v[184:187], 0
    v_mfma_f32_16x16x32_bf16 v[28:31], a[16:19], v[200:203], 0
    s_waitcnt lgkmcnt(2)
    v_mfma_f32_16x16x32_bf16 v[20:23], a[20:23], v[172:175], v[20:23]
    v_mfma_f32_16x16x32_bf16 v[24:27], a[20:23], v[188:191], v[24:27]
    v_mfma_f32_16x16x32_bf16 v[28:31], a[20:23], v[204:207], v[28:31]
    s_waitcnt lgkmcnt(1)
    v_mfma_f32_16x16x32_bf16 v[20:23], a[24:27], v[176:179], v[20:23]
    v_mfma_f32_16x16x32_bf16 v[24:27], a[24:27], v[192:195], v[24:27]
    v_mfma_f32_16x16x32_bf16 v[28:31], a[24:27], v[208:211], v[28:31]
    s_waitcnt lgkmcnt(0)
    v_mfma_f32_16x16x32_bf16 v[20:23], a[28:31], v[180:183], v[20:23]
    v_mfma_f32_16x16x32_bf16 v[24:27], a[28:31], v[196:199], v[24:27]
    v_mfma_f32_16x16x32_bf16 v[28:31], a[28:31], v[212:215], v[28:31]
    ds_read_b128 a[16:19], v2 offset:512
    ds_read_b128 a[20:23], v2 offset:576
    ds_read_b128 a[24:27], v2 offset:640
    ds_read_b128 a[28:31], v2 offset:704
    s_waitcnt lgkmcnt(3)
    v_mfma_f32_16x16x32_bf16 v[32:35], a[16:19], v[168:171], 0
    v_mfma_f32_16x16x32_bf16 v[36:39], a[16:19], v[184:187], 0
    v_mfma_f32_16x16x32_bf16 v[40:43], a[16:19], v[200:203], 0
    s_waitcnt lgkmcnt(2)
    v_mfma_f32_16x16x32_bf16 v[32:35], a[20:23], v[172:175], v[32:35]
    v_mfma_f32_16x16x32_bf16 v[36:39], a[20:23], v[188:191], v[36:39]
    v_mfma_f32_16x16x32_bf16 v[40:43], a[20:23], v[204:207], v[40:43]
    s_waitcnt lgkmcnt(1)
    v_mfma_f32_16x16x32_bf16 v[32:35], a[24:27], v[176:179], v[32:35]
    v_mfma_f32_16x16x32_bf16 v[36:39], a[24:27], v[192:195], v[36:39]
    v_mfma_f32_16x16x32_bf16 v[40:43], a[24:27], v[208:211], v[40:43]
    s_waitcnt lgkmcnt(0)
    v_mfma_f32_16x16x32_bf16 v[32:35], a[28:31], v[180:183], v[32:35]
    v_mfma_f32_16x16x32_bf16 v[36:39], a[28:31], v[196:199], v[36:39]
    v_mfma_f32_16x16x32_bf16 v[40:43], a[28:31], v[212:215], v[40:43]
    v_max3_f32 v5, v20, v21, v22
    s_nop 4
    v_max3_f32 v5, v5, v23, v32
    v_max3_f32 v5, v5, v33, v34
    v_max_f32 v5, v5, v35
    v_mov_b32 v6, v5
    v_mov_b32 v7, v5
    s_nop 1
    v_permlane32_swap_b32 v6, v7
    v_max_f32 v5, v6, v7
    v_mov_b32 v6, v5
    v_mov_b32 v7, v5
    s_nop 1
    v_permlane16_swap_b32 v6, v7
    v_max_f32 v5, v6, v7
    v_add_f32 v5, 0x40e00000, v5
    v_max_f32_e64 v5, v5, -v8
    v_sub_f32_e64 v6, -v8, v5
    v_exp_f32 v6, v6
    v_sub_f32 v8, 0, v5
    v_sub_f32 v9, 0, v5
    v_sub_f32 v10, 0, v5
    v_sub_f32 v11, 0, v5
    v_mul_f32 v72, v72, v6
    v_mul_f32 v73, v73, v6
    v_mul_f32 v74, v74, v6
    v_mul_f32 v75, v75, v6
    v_mul_f32 v76, v76, v6
    v_mul_f32 v77, v77, v6
    v_mul_f32 v78, v78, v6
    v_mul_f32 v79, v79, v6
    v_mul_f32 v80, v80, v6
    v_mul_f32 v81, v81, v6
    v_mul_f32 v82, v82, v6
    v_mul_f32 v83, v83, v6
    v_mul_f32 v84, v84, v6
    v_mul_f32 v85, v85, v6
    v_mul_f32 v86, v86, v6
    v_mul_f32 v87, v87, v6
    v_mul_f32 v88, v88, v6
    v_mul_f32 v89, v89, v6
    v_mul_f32 v90, v90, v6
    v_mul_f32 v91, v91, v6
    v_mul_f32 v92, v92, v6
    v_mul_f32 v93, v93, v6
    v_mul_f32 v94, v94, v6
    v_mul_f32 v95, v95, v6
    v_mul_f32 v96, v96, v6
    v_mul_f32 v97, v97, v6
    v_mul_f32 v98, v98, v6
    v_mul_f32 v99, v99, v6
    v_mul_f32 v100, v100, v6
    v_mul_f32 v101, v101, v6
    v_mul_f32 v102, v102, v6
    v_mul_f32 v103, v103, v6
    v_accvgpr_read_b32 v7, a0
    v_mul_f32 v7, v7, v6
    v_accvgpr_write_b32 a0, v7
    v_accvgpr_read_b32 v7, a1
    v_mul_f32 v7, v7, v6
    v_accvgpr_write_b32 a1, v7
    v_accvgpr_read_b32 v7, a2
    v_mul_f32 v7, v7, v6
    v_accvgpr_write_b32 a2, v7
    v_accvgpr_read_b32 v7, a3
    v_mul_f32 v7, v7, v6
    v_accvgpr_write_b32 a3, v7
    v_add_f32 v20, v20, v8
    v_add_f32 v21, v21, v8
    v_add_f32 v22, v22, v8
    v_add_f32 v23, v23, v8
    v_add_f32 v32, v32, v8
    v_add_f32 v33, v33, v8
    v_add_f32 v34, v34, v8
    v_add_f32 v35, v35, v8
    v_exp_f32 v20, v20
    v_exp_f32 v21, v21
    v_exp_f32 v22, v22
    v_exp_f32 v23, v23
    v_exp_f32 v32, v32
    v_exp_f32 v33, v33
    v_exp_f32 v34, v34
    v_exp_f32 v35, v35
    v_cvt_pk_bf16_f32 v20, v20, v21
    v_cvt_pk_bf16_f32 v21, v22, v23
    v_cvt_pk_bf16_f32 v22, v32, v33
    v_cvt_pk_bf16_f32 v23, v34, v35
    v_max3_f32 v5, v24, v25, v26
    v_max3_f32 v5, v5, v27, v36
    v_max3_f32 v5, v5, v37, v38
    v_max_f32 v5, v5, v39
    v_mov_b32 v6, v5
    v_mov_b32 v7, v5
    s_nop 1
    v_permlane32_swap_b32 v6, v7
    v_max_f32 v5, v6, v7
    v_mov_b32 v6, v5
    v_mov_b32 v7, v5
    s_nop 1
    v_permlane16_swap_b32 v6, v7
    v_max_f32 v5, v6, v7
    v_add_f32 v5, 0x40e00000, v5
    v_max_f32_e64 v5, v5, -v12
    v_sub_f32_e64 v6, -v12, v5
    v_exp_f32 v6, v6
    v_sub_f32 v12, 0, v5
    v_sub_f32 v13, 0, v5
    v_sub_f32 v14, 0, v5
    v_sub_f32 v15, 0, v5
    v_mul_f32 v104, v104, v6
    v_mul_f32 v105, v105, v6
    v_mul_f32 v106, v106, v6
    v_mul_f32 v107, v107, v6
    v_mul_f32 v108, v108, v6
    v_mul_f32 v109, v109, v6
    v_mul_f32 v110, v110, v6
    v_mul_f32 v111, v111, v6
    v_mul_f32 v112, v112, v6
    v_mul_f32 v113, v113, v6
    v_mul_f32 v114, v114, v6
    v_mul_f32 v115, v115, v6
    v_mul_f32 v116, v116, v6
    v_mul_f32 v117, v117, v6
    v_mul_f32 v118, v118, v6
    v_mul_f32 v119, v119, v6
    v_mul_f32 v120, v120, v6
    v_mul_f32 v121, v121, v6
    v_mul_f32 v122, v122, v6
    v_mul_f32 v123, v123, v6
    v_mul_f32 v124, v124, v6
    v_mul_f32 v125, v125, v6
    v_mul_f32 v126, v126, v6
    v_mul_f32 v127, v127, v6
    v_mul_f32 v128, v128, v6
    v_mul_f32 v129, v129, v6
    v_mul_f32 v130, v130, v6
    v_mul_f32 v131, v131, v6
    v_mul_f32 v132, v132, v6
    v_mul_f32 v133, v133, v6
    v_mul_f32 v134, v134, v6
    v_mul_f32 v135, v135, v6
    v_accvgpr_read_b32 v7, a4
    v_mul_f32 v7, v7, v6
    v_accvgpr_write_b32 a4, v7
    v_accvgpr_read_b32 v7, a5
    v_mul_f32 v7, v7, v6
    v_accvgpr_write_b32 a5, v7
    v_accvgpr_read_b32 v7, a6
    v_mul_f32 v7, v7, v6
    v_accvgpr_write_b32 a6, v7
    v_accvgpr_read_b32 v7, a7
    v_mul_f32 v7, v7, v6
    v_accvgpr_write_b32 a7, v7
    v_add_f32 v24, v24, v12
    v_add_f32 v25, v25, v12
    v_add_f32 v26, v26, v12
    v_add_f32 v27, v27, v12
    v_add_f32 v36, v36, v12
    v_add_f32 v37, v37, v12
    v_add_f32 v38, v38, v12
    v_add_f32 v39, v39, v12
    v_exp_f32 v24, v24
    v_exp_f32 v25, v25
    v_exp_f32 v26, v26
    v_exp_f32 v27, v27
    v_exp_f32 v36, v36
    v_exp_f32 v37, v37
    v_exp_f32 v38, v38
    v_exp_f32 v39, v39
    v_cvt_pk_bf16_f32 v24, v24, v25
    v_cvt_pk_bf16_f32 v25, v26, v27
    v_cvt_pk_bf16_f32 v26, v36, v37
    v_cvt_pk_bf16_f32 v27, v38, v39
    v_max3_f32 v5, v28, v29, v30
    v_max3_f32 v5, v5, v31, v40
    v_max3_f32 v5, v5, v41, v42
    v_max_f32 v5, v5, v43
    v_mov_b32 v6, v5
    v_mov_b32 v7, v5
    s_nop 1
    v_permlane32_swap_b32 v6, v7
    v_max_f32 v5, v6, v7
    v_mov_b32 v6, v5
    v_mov_b32 v7, v5
    s_nop 1
    v_permlane16_swap_b32 v6, v7
    v_max_f32 v5, v6, v7
    v_add_f32 v5, 0x40e00000, v5
    v_max_f32_e64 v5, v5, -v16
    v_sub_f32_e64 v6, -v16, v5
    v_exp_f32 v6, v6
    v_sub_f32 v16, 0, v5
    v_sub_f32 v17, 0, v5
    v_sub_f32 v18, 0, v5
    v_sub_f32 v19, 0, v5
    v_mul_f32 v136, v136, v6
    v_mul_f32 v137, v137, v6
    v_mul_f32 v138, v138, v6
    v_mul_f32 v139, v139, v6
    v_mul_f32 v140, v140, v6
    v_mul_f32 v141, v141, v6
    v_mul_f32 v142, v142, v6
    v_mul_f32 v143, v143, v6
    v_mul_f32 v144, v144, v6
    v_mul_f32 v145, v145, v6
    v_mul_f32 v146, v146, v6
    v_mul_f32 v147, v147, v6
    v_mul_f32 v148, v148, v6
    v_mul_f32 v149, v149, v6
    v_mul_f32 v150, v150, v6
    v_mul_f32 v151, v151, v6
    v_mul_f32 v152, v152, v6
    v_mul_f32 v153, v153, v6
    v_mul_f32 v154, v154, v6
    v_mul_f32 v155, v155, v6
    v_mul_f32 v156, v156, v6
    v_mul_f32 v157, v157, v6
    v_mul_f32 v158, v158, v6
    v_mul_f32 v159, v159, v6
    v_mul_f32 v160, v160, v6
    v_mul_f32 v161, v161, v6
    v_mul_f32 v162, v162, v6
    v_mul_f32 v163, v163, v6
    v_mul_f32 v164, v164, v6
    v_mul_f32 v165, v165, v6
    v_mul_f32 v166, v166, v6
    v_mul_f32 v167, v167, v6
    v_accvgpr_read_b32 v7, a8
    v_mul_f32 v7, v7, v6
    v_accvgpr_write_b32 a8, v7
    v_accvgpr_read_b32 v7, a9
    v_mul_f32 v7, v7, v6
    v_accvgpr_write_b32 a9, v7
    v_accvgpr_read_b32 v7, a10
    v_mul_f32 v7, v7, v6
    v_accvgpr_write_b32 a10, v7
    v_accvgpr_read_b32 v7, a11
    v_mul_f32 v7, v7, v6
    v_accvgpr_write_b32 a11, v7
    v_add_f32 v28, v28, v16
    v_add_f32 v29, v29, v16
    v_add_f32 v30, v30, v16
    v_add_f32 v31, v31, v16
    v_add_f32 v40, v40, v16
    v_add_f32 v41, v41, v16
    v_add_f32 v42, v42, v16
    v_add_f32 v43, v43, v16
    v_exp_f32 v28, v28
    v_exp_f32 v29, v29
    v_exp_f32 v30, v30
    v_exp_f32 v31, v31
    v_exp_f32 v40, v40
    v_exp_f32 v41, v41
    v_exp_f32 v42, v42
    v_exp_f32 v43, v43
    v_cvt_pk_bf16_f32 v28, v28, v29
    v_cvt_pk_bf16_f32 v29, v30, v31
    v_cvt_pk_bf16_f32 v30, v40, v41
    v_cvt_pk_bf16_f32 v31, v42, v43
    ds_read_b128 a[16:19], v2 offset:8448
    ds_read_b128 a[20:23], v2 offset:8512
    ds_read_b128 a[24:27], v2 offset:8576
    ds_read_b128 a[28:31], v2 offset:8640
    s_waitcnt lgkmcnt(3)
    v_mfma_f32_16x16x32_bf16 v[44:47], a[16:19], v[168:171], v[8:11]
    v_mfma_f32_16x16x32_bf16 v[48:51], a[16:19], v[184:187], v[12:15]
    v_mfma_f32_16x16x32_bf16 v[52:55], a[16:19], v[200:203], v[16:19]
    s_waitcnt lgkmcnt(2)
    v_mfma_f32_16x16x32_bf16 v[44:47], a[20:23], v[172:175], v[44:47]
    v_mfma_f32_16x16x32_bf16 v[48:51], a[20:23], v[188:191], v[48:51]
    v_mfma_f32_16x16x32_bf16 v[52:55], a[20:23], v[204:207], v[52:55]
    s_waitcnt lgkmcnt(1)
    v_mfma_f32_16x16x32_bf16 v[44:47], a[24:27], v[176:179], v[44:47]
    v_mfma_f32_16x16x32_bf16 v[48:51], a[24:27], v[192:195], v[48:51]
    v_mfma_f32_16x16x32_bf16 v[52:55], a[24:27], v[208:211], v[52:55]
    s_waitcnt lgkmcnt(0)
    v_mfma_f32_16x16x32_bf16 v[44:47], a[28:31], v[180:183], v[44:47]
    v_mfma_f32_16x16x32_bf16 v[48:51], a[28:31], v[196:199], v[48:51]
    v_mfma_f32_16x16x32_bf16 v[52:55], a[28:31], v[212:215], v[52:55]
    ds_read_b128 a[16:19], v2 offset:8960
    ds_read_b128 a[20:23], v2 offset:9024
    ds_read_b128 a[24:27], v2 offset:9088
    ds_read_b128 a[28:31], v2 offset:9152
    s_waitcnt lgkmcnt(3)
    v_mfma_f32_16x16x32_bf16 v[56:59], a[16:19], v[168:171], v[8:11]
    v_mfma_f32_16x16x32_bf16 v[60:63], a[16:19], v[184:187], v[12:15]
    v_mfma_f32_16x16x32_bf16 v[64:67], a[16:19], v[200:203], v[16:19]
    s_waitcnt lgkmcnt(2)
    v_mfma_f32_16x16x32_bf16 v[56:59], a[20:23], v[172:175], v[56:59]
    v_mfma_f32_16x16x32_bf16 v[60:63], a[20:23], v[188:191], v[60:63]
    v_mfma_f32_16x16x32_bf16 v[64:67], a[20:23], v[204:207], v[64:67]
    s_waitcnt lgkmcnt(1)
    v_mfma_f32_16x16x32_bf16 v[56:59], a[24:27], v[176:179], v[56:59]
    v_mfma_f32_16x16x32_bf16 v[60:63], a[24:27], v[192:195], v[60:63]
    v_mfma_f32_16x16x32_bf16 v[64:67], a[24:27], v[208:211], v[64:67]
    s_waitcnt lgkmcnt(0)
    v_mfma_f32_16x16x32_bf16 v[56:59], a[28:31], v[180:183], v[56:59]
    v_mfma_f32_16x16x32_bf16 v[60:63], a[28:31], v[196:199], v[60:63]
    v_mfma_f32_16x16x32_bf16 v[64:67], a[28:31], v[212:215], v[64:67]
    ds_read_b64_tr_b16 a[24:25], v3 offset:0
    ds_read_b64_tr_b16 a[26:27], v3 offset:512
    ds_read_b64_tr_b16 a[28:29], v3 offset:32
    ds_read_b64_tr_b16 a[30:31], v3 offset:544
    ds_read_b64_tr_b16 a[32:33], v3 offset:64
    ds_read_b64_tr_b16 a[34:35], v3 offset:576
    ds_read_b64_tr_b16 a[36:37], v3 offset:96
    ds_read_b64_tr_b16 a[38:39], v3 offset:608
    s_waitcnt lgkmcnt(0)
    s_nop 15
    s_branch L_k_c_ret0
L_k_c_rare1:
    s_waitcnt lgkmcnt(0)
    s_nop 15
    v_subrev_u32 v68, s56, v2
    ds_read_b128 a[16:19], v68 offset:8448
    ds_read_b128 a[20:23], v68 offset:8512
    ds_read_b128 a[24:27], v68 offset:8576
    ds_read_b128 a[28:31], v68 offset:8640
    s_waitcnt lgkmcnt(3)
    v_mfma_f32_16x16x32_bf16 v[44:47], a[16:19], v[168:171], 0
    v_mfma_f32_16x16x32_bf16 v[48:51], a[16:19], v[184:187], 0
    v_mfma_f32_16x16x32_bf16 v[52:55], a[16:19], v[200:203], 0
    s_waitcnt lgkmcnt(2)
    v_mfma_f32_16x16x32_bf16 v[44:47], a[20:23], v[172:175], v[44:47]
    v_mfma_f32_16x16x32_bf16 v[48:51], a[20:23], v[188:191], v[48:51]
    v_mfma_f32_16x16x32_bf16 v[52:55], a[20:23], v[204:207], v[52:55]
    s_waitcnt lgkmcnt(1)
    v_mfma_f32_16x16x32_bf16 v[44:47], a[24:27], v[176:179], v[44:47]
    v_mfma_f32_16x16x32_bf16 v[48:51], a[24:27], v[192:195], v[48:51]
    v_mfma_f32_16x16x32_bf16 v[52:55], a[24:27], v[208:211], v[52:55]
    s_waitcnt lgkmcnt(0)
    v_mfma_f32_16x16x32_bf16 v[44:47], a[28:31], v[180:183], v[44:47]
    v_mfma_f32_16x16x32_bf16 v[48:51], a[28:31], v[196:199], v[48:51]
    v_mfma_f32_16x16x32_bf16 v[52:55], a[28:31], v[212:215], v[52:55]
    ds_read_b128 a[16:19], v68 offset:8960
    ds_read_b128 a[20:23], v68 offset:9024
    ds_read_b128 a[24:27], v68 offset:9088
    ds_read_b128 a[28:31], v68 offset:9152
    s_waitcnt lgkmcnt(3)
    v_mfma_f32_16x16x32_bf16 v[56:59], a[16:19], v[168:171], 0
    v_mfma_f32_16x16x32_bf16 v[60:63], a[16:19], v[184:187], 0
    v_mfma_f32_16x16x32_bf16 v[64:67], a[16:19], v[200:203], 0
    s_waitcnt lgkmcnt(2)
    v_mfma_f32_16x16x32_bf16 v[56:59], a[20:23], v[172:175], v[56:59]
    v_mfma_f32_16x16x32_bf16 v[60:63], a[20:23], v[188:191], v[60:63]
    v_mfma_f32_16x16x32_bf16 v[64:67], a[20:23], v[204:207], v[64:67]
    s_waitcnt lgkmcnt(1)
    v_mfma_f32_16x16x32_bf16 v[56:59], a[24:27], v[176:179], v[56:59]
    v_mfma_f32_16x16x32_bf16 v[60:63], a[24:27], v[192:195], v[60:63]
    v_mfma_f32_16x16x32_bf16 v[64:67], a[24:27], v[208:211], v[64:67]
    s_waitcnt lgkmcnt(0)
    v_mfma_f32_16x16x32_bf16 v[56:59], a[28:31], v[180:183], v[56:59]
    v_mfma_f32_16x16x32_bf16 v[60:63], a[28:31], v[196:199], v[60:63]
    v_mfma_f32_16x16x32_bf16 v[64:67], a[28:31], v[212:215], v[64:67]
    v_max3_f32 v5, v44, v45, v46
    s_nop 4
    v_max3_f32 v5, v5, v47, v56
    v_max3_f32 v5, v5, v57, v58
    v_max_f32 v5, v5, v59
    v_mov_b32 v6, v5
    v_mov_b32 v7, v5
    s_nop 1
    v_permlane32_swap_b32 v6, v7
    v_max_f32 v5, v6, v7
    v_mov_b32 v6, v5
    v_mov_b32 v7, v5
    s_nop 1
    v_permlane16_swap_b32 v6, v7
    v_max_f32 v5, v6, v7
    v_add_f32 v5, 0x40e00000, v5
    v_max_f32_e64 v5, v5, -v8
    v_sub_f32_e64 v6, -v8, v5
    v_exp_f32 v6, v6
    v_sub_f32 v8, 0, v5
    v_sub_f32 v9, 0, v5
    v_sub_f32 v10, 0, v5
    v_sub_f32 v11, 0, v5
    v_mul_f32 v72, v72, v6
    v_mul_f32 v73, v73, v6
    v_mul_f32 v74, v74, v6
    v_mul_f32 v75, v75, v6
    v_mul_f32 v76, v76, v6
    v_mul_f32 v77, v77, v6
    v_mul_f32 v78, v78, v6
    v_mul_f32 v79, v79, v6
    v_mul_f32 v80, v80, v6
    v_mul_f32 v81, v81, v6
    v_mul_f32 v82, v82, v6
    v_mul_f32 v83, v83, v6
    v_mul_f32 v84, v84, v6
    v_mul_f32 v85, v85, v6
    v_mul_f32 v86, v86, v6
    v_mul_f32 v87, v87, v6
    v_mul_f32 v88, v88, v6
    v_mul_f32 v89, v89, v6
    v_mul_f32 v90, v90, v6
    v_mul_f32 v91, v91, v6
    v_mul_f32 v92, v92, v6
    v_mul_f32 v93, v93, v6
    v_mul_f32 v94, v94, v6
    v_mul_f32 v95, v95, v6
    v_mul_f32 v96, v96, v6
    v_mul_f32 v97, v97, v6
    v_mul_f32 v98, v98, v6
    v_mul_f32 v99, v99, v6
    v_mul_f32 v100, v100, v6
    v_mul_f32 v101, v101, v6
    v_mul_f32 v102, v102, v6
    v_mul_f32 v103, v103, v6
    v_accvgpr_read_b32 v7, a0
    v_mul_f32 v7, v7, v6
    v_accvgpr_write_b32 a0, v7
    v_accvgpr_read_b32 v7, a1
    v_mul_f32 v7, v7, v6
    v_accvgpr_write_b32 a1, v7
    v_accvgpr_read_b32 v7, a2
    v_mul_f32 v7, v7, v6
    v_accvgpr_write_b32 a2, v7
    v_accvgpr_read_b32 v7, a3
    v_mul_f32 v7, v7, v6
    v_accvgpr_write_b32 a3, v7
    v_add_f32 v44, v44, v8
    v_add_f32 v45, v45, v8
    v_add_f32 v46, v46, v8
    v_add_f32 v47, v47, v8
    v_add_f32 v56, v56, v8
    v_add_f32 v57, v57, v8
    v_add_f32 v58, v58, v8
    v_add_f32 v59, v59, v8
    v_exp_f32 v44, v44
    v_exp_f32 v45, v45
    v_exp_f32 v46, v46
    v_exp_f32 v47, v47
    v_exp_f32 v56, v56
    v_exp_f32 v57, v57
    v_exp_f32 v58, v58
    v_exp_f32 v59, v59
    v_cvt_pk_bf16_f32 v44, v44, v45
    v_cvt_pk_bf16_f32 v45, v46, v47
    v_cvt_pk_bf16_f32 v46, v56, v57
    v_cvt_pk_bf16_f32 v47, v58, v59
    v_max3_f32 v5, v48, v49, v50
    v_max3_f32 v5, v5, v51, v60
    v_max3_f32 v5, v5, v61, v62
    v_max_f32 v5, v5, v63
    v_mov_b32 v6, v5
    v_mov_b32 v7, v5
    s_nop 1
    v_permlane32_swap_b32 v6, v7
    v_max_f32 v5, v6, v7
    v_mov_b32 v6, v5
    v_mov_b32 v7, v5
    s_nop 1
    v_permlane16_swap_b32 v6, v7
    v_max_f32 v5, v6, v7
    v_add_f32 v5, 0x40e00000, v5
    v_max_f32_e64 v5, v5, -v12
    v_sub_f32_e64 v6, -v12, v5
    v_exp_f32 v6, v6
    v_sub_f32 v12, 0, v5
    v_sub_f32 v13, 0, v5
    v_sub_f32 v14, 0, v5
    v_sub_f32 v15, 0, v5
    v_mul_f32 v104, v104, v6
    v_mul_f32 v105, v105, v6
    v_mul_f32 v106, v106, v6
    v_mul_f32 v107, v107, v6
    v_mul_f32 v108, v108, v6
    v_mul_f32 v109, v109, v6
    v_mul_f32 v110, v110, v6
    v_mul_f32 v111, v111, v6
    v_mul_f32 v112, v112, v6
    v_mul_f32 v113, v113, v6
    v_mul_f32 v114, v114, v6
    v_mul_f32 v115, v115, v6
    v_mul_f32 v116, v116, v6
    v_mul_f32 v117, v117, v6
    v_mul_f32 v118, v118, v6
    v_mul_f32 v119, v119, v6
    v_mul_f32 v120, v120, v6
    v_mul_f32 v121, v121, v6
    v_mul_f32 v122, v122, v6
    v_mul_f32 v123, v123, v6
    v_mul_f32 v124, v124, v6
    v_mul_f32 v125, v125, v6
    v_mul_f32 v126, v126, v6
    v_mul_f32 v127, v127, v6
    v_mul_f32 v128, v128, v6
    v_mul_f32 v129, v129, v6
    v_mul_f32 v130, v130, v6
    v_mul_f32 v131, v131, v6
    v_mul_f32 v132, v132, v6
    v_mul_f32 v133, v133, v6
    v_mul_f32 v134, v134, v6
    v_mul_f32 v135, v135, v6
    v_accvgpr_read_b32 v7, a4
    v_mul_f32 v7, v7, v6
    v_accvgpr_write_b32 a4, v7
    v_accvgpr_read_b32 v7, a5
    v_mul_f32 v7, v7, v6
    v_accvgpr_write_b32 a5, v7
    v_accvgpr_read_b32 v7, a6
    v_mul_f32 v7, v7, v6
    v_accvgpr_write_b32 a6, v7
    v_accvgpr_read_b32 v7, a7
    v_mul_f32 v7, v7, v6
    v_accvgpr_write_b32 a7, v7
    v_add_f32 v48, v48, v12
    v_add_f32 v49, v49, v12
    v_add_f32 v50, v50, v12
    v_add_f32 v51, v51, v12
    v_add_f32 v60, v60, v12
    v_add_f32 v61, v61, v12
    v_add_f32 v62, v62, v12
    v_add_f32 v63, v63, v12
    v_exp_f32 v48, v48
    v_exp_f32 v49, v49
    v_exp_f32 v50, v50
    v_exp_f32 v51, v51
    v_exp_f32 v60, v60
    v_exp_f32 v61, v61
    v_exp_f32 v62, v62
    v_exp_f32 v63, v63
    v_cvt_pk_bf16_f32 v48, v48, v49
    v_cvt_pk_bf16_f32 v49, v50, v51
    v_cvt_pk_bf16_f32 v50, v60, v61
    v_cvt_pk_bf16_f32 v51, v62, v63
    v_max3_f32 v5, v52, v53, v54
    v_max3_f32 v5, v5, v55, v64
    v_max3_f32 v5, v5, v65, v66
    v_max_f32 v5, v5, v67
    v_mov_b32 v6, v5
    v_mov_b32 v7, v5
    s_nop 1
    v_permlane32_swap_b32 v6, v7
    v_max_f32 v5, v6, v7
    v_mov_b32 v6, v5
    v_mov_b32 v7, v5
    s_nop 1
    v_permlane16_swap_b32 v6, v7
    v_max_f32 v5, v6, v7
    v_add_f32 v5, 0x40e00000, v5
    v_max_f32_e64 v5, v5, -v16
    v_sub_f32_e64 v6, -v16, v5
    v_exp_f32 v6, v6
    v_sub_f32 v16, 0, v5
    v_sub_f32 v17, 0, v5
    v_sub_f32 v18, 0, v5
    v_sub_f32 v19, 0, v5
    v_mul_f32 v136, v136, v6
    v_mul_f32 v137, v137, v6
    v_mul_f32 v138, v138, v6
    v_mul_f32 v139, v139, v6
    v_mul_f32 v140, v140, v6
    v_mul_f32 v141, v141, v6
    v_mul_f32 v142, v142, v6
    v_mul_f32 v143, v143, v6
    v_mul_f32 v144, v144, v6
    v_mul_f32 v145, v145, v6
    v_mul_f32 v146, v146, v6
    v_mul_f32 v147, v147, v6
    v_mul_f32 v148, v148, v6
    v_mul_f32 v149, v149, v6
    v_mul_f32 v150, v150, v6
    v_mul_f32 v151, v151, v6
    v_mul_f32 v152, v152, v6
    v_mul_f32 v153, v153, v6
    v_mul_f32 v154, v154, v6
    v_mul_f32 v155, v155, v6
    v_mul_f32 v156, v156, v6
    v_mul_f32 v157, v157, v6
    v_mul_f32 v158, v158, v6
    v_mul_f32 v159, v159, v6
    v_mul_f32 v160, v160, v6
    v_mul_f32 v161, v161, v6
    v_mul_f32 v162, v162, v6
    v_mul_f32 v163, v163, v6
    v_mul_f32 v164, v164, v6
    v_mul_f32 v165, v165, v6
    v_mul_f32 v166, v166, v6
    v_mul_f32 v167, v167, v6
    v_accvgpr_read_b32 v7, a8
    v_mul_f32 v7, v7, v6
    v_accvgpr_write_b32 a8, v7
    v_accvgpr_read_b32 v7, a9
    v_mul_f32 v7, v7, v6
    v_accvgpr_write_b32 a9, v7
    v_accvgpr_read_b32 v7, a10
    v_mul_f32 v7, v7, v6
    v_accvgpr_write_b32 a10, v7
    v_accvgpr_read_b32 v7, a11
    v_mul_f32 v7, v7, v6
    v_accvgpr_write_b32 a11, v7
    v_add_f32 v52, v52, v16
    v_add_f32 v53, v53, v16
    v_add_f32 v54, v54, v16
    v_add_f32 v55, v55, v16
    v_add_f32 v64, v64, v16
    v_add_f32 v65, v65, v16
    v_add_f32 v66, v66, v16
    v_add_f32 v67, v67, v16
    v_exp_f32 v52, v52
    v_exp_f32 v53, v53
    v_exp_f32 v54, v54
    v_exp_f32 v55, v55
    v_exp_f32 v64, v64
    v_exp_f32 v65, v65
    v_exp_f32 v66, v66
    v_exp_f32 v67, v67
    v_cvt_pk_bf16_f32 v52, v52, v53
    v_cvt_pk_bf16_f32 v53, v54, v55
    v_cvt_pk_bf16_f32 v54, v64, v65
    v_cvt_pk_bf16_f32 v55, v66, v67
    ds_read_b128 a[16:19], v2 offset:0
    ds_read_b128 a[20:23], v2 offset:64
    ds_read_b128 a[24:27], v2 offset:128
    ds_read_b128 a[28:31], v2 offset:192
    s_waitcnt lgkmcnt(3)
    v_mfma_f32_16x16x32_bf16 v[20:23], a[16:19], v[168:171], v[8:11]
    v_mfma_f32_16x16x32_bf16 v[24:27], a[16:19], v[184:187], v[12:15]
    v_mfma_f32_16x16x32_bf16 v[28:31], a[16:19], v[200:203], v[16:19]
    s_waitcnt lgkmcnt(2)
    v_mfma_f32_16x16x32_bf16 v[20:23], a[20:23], v[172:175], v[20:23]
    v_mfma_f32_16x16x32_bf16 v[24:27], a[20:23], v[188:191], v[24:27]
    v_mfma_f32_16x16x32_bf16 v[28:31], a[20:23], v[204:207], v[28:31]
    s_waitcnt lgkmcnt(1)
    v_mfma_f32_16x16x32_bf16 v[20:23], a[24:27], v[176:179], v[20:23]
    v_mfma_f32_16x16x32_bf16 v[24:27], a[24:27], v[192:195], v[24:27]
    v_mfma_f32_16x16x32_bf16 v[28:31], a[24:27], v[208:211], v[28:31]
    s_waitcnt lgkmcnt(0)
    v_mfma_f32_16x16x32_bf16 v[20:23], a[28:31], v[180:183], v[20:23]
    v_mfma_f32_16x16x32_bf16 v[24:27], a[28:31], v[196:199], v[24:27]
    v_mfma_f32_16x16x32_bf16 v[28:31], a[28:31], v[212:215], v[28:31]
    ds_read_b128 a[16:19], v2 offset:512
    ds_read_b128 a[20:23], v2 offset:576
    ds_read_b128 a[24:27], v2 offset:640
    ds_read_b128 a[28:31], v2 offset:704
    s_waitcnt lgkmcnt(3)
    v_mfma_f32_16x16x32_bf16 v[32:35], a[16:19], v[168:171], v[8:11]
    v_mfma_f32_16x16x32_bf16 v[36:39], a[16:19], v[184:187], v[12:15]
    v_mfma_f32_16x16x32_bf16 v[40:43], a[16:19], v[200:203], v[16:19]
    s_waitcnt lgkmcnt(2)
    v_mfma_f32_16x16x32_bf16 v[32:35], a[20:23], v[172:175], v[32:35]
    v_mfma_f32_16x16x32_bf16 v[36:39], a[20:23], v[188:191], v[36:39]
    v_mfma_f32_16x16x32_bf16 v[40:43], a[20:23], v[204:207], v[40:43]
    s_waitcnt lgkmcnt(1)
    v_mfma_f32_16x16x32_bf16 v[32:35], a[24:27], v[176:179], v[32:35]
    v_mfma_f32_16x16x32_bf16 v[36:39], a[24:27], v[192:195], v[36:39]
    v_mfma_f32_16x16x32_bf16 v[40:43], a[24:27], v[208:211], v[40:43]
    s_waitcnt lgkmcnt(0)
    v_mfma_f32_16x16x32_bf16 v[32:35], a[28:31], v[180:183], v[32:35]
    v_mfma_f32_16x16x32_bf16 v[36:39], a[28:31], v[196:199], v[36:39]
    v_mfma_f32_16x16x32_bf16 v[40:43], a[28:31], v[212:215], v[40:43]
    ds_read_b64_tr_b16 a[24:25], v3 offset:8448
    ds_read_b64_tr_b16 a[26:27], v3 offset:8960
    ds_read_b64_tr_b16 a[28:29], v3 offset:8480
    ds_read_b64_tr_b16 a[30:31], v3 offset:8992
    ds_read_b64_tr_b16 a[32:33], v3 offset:8512
    ds_read_b64_tr_b16 a[34:35], v3 offset:9024
    ds_read_b64_tr_b16 a[16:17], v3 offset:8544
    ds_read_b64_tr_b16 a[18:19], v3 offset:9056
    s_waitcnt lgkmcnt(0)
    s_nop 15
    s_branch L_k_c_ret1
L_k_spin_cq0:
    ds_read_b32 v70, v0 offset:4
    s_waitcnt lgkmcnt(0)
    v_cmp_gt_u32 vcc, s52, v70
    s_cbranch_vccz L_k_ret_cq0
    s_sub_u32 s80, s80, 1
    s_cbranch_scc0 L_k_spin_cq0
    s_endpgm
L_k_spin_cq2:
    ds_read_b32 v70, v0 offset:0
    s_waitcnt lgkmcnt(0)
    v_cmp_gt_u32 vcc, s52, v70
    s_cbranch_vccz L_k_ret_cq2
    s_sub_u32 s80, s80, 1
    s_cbranch_scc0 L_k_spin_cq2
    s_endpgm
L_k_spin_cq4:
    ds_read_b32 v70, v0 offset:4
    s_waitcnt lgkmcnt(0)
    v_cmp_gt_u32 vcc, s52, v70
    s_cbranch_vccz L_k_ret_cq4
    s_sub_u32 s80, s80, 1
    s_cbranch_scc0 L_k_spin_cq4
    s_endpgm
L_k_spin_cq6:
    ds_read_b32 v70, v0 offset:0
    s_waitcnt lgkmcnt(0)
    v_cmp_gt_u32 vcc, s52, v70
    s_cbranch_vccz L_k_ret_cq6
    s_sub_u32 s80, s80, 1
    s_cbranch_scc0 L_k_spin_cq6
    s_endpgm
L_k_spin_cv:
    ds_read_b64 v[70:71], v0 offset:8
    s_waitcnt lgkmcnt(0)
    v_min_u32 v70, v70, v71
    v_cmp_gt_u32 vcc, s52, v70
    s_cbranch_vccz L_k_ret_cv
    s_sleep 1
    s_sub_u32 s80, s80, 1
    s_cbranch_scc0 L_k_spin_cv
    s_endpgm
L_k_spin_ck:
    ds_read_b64 v[70:71], v0 offset:8
    s_waitcnt lgkmcnt(0)
    v_min_u32 v70, v70, v71
    v_cmp_gt_u32 vcc, s53, v70
    s_cbranch_vccz L_k_ret_ck
    s_sleep 1
    s_sub_u32 s80, s80, 1
    s_cbranch_scc0 L_k_spin_ck
    s_endpgm
L_k_spin_po1:
    ds_read_b32 v70, v0 offset:112
    s_waitcnt lgkmcnt(0)
    v_cmp_gt_u32 vcc, 3, v70
    s_cbranch_vccz L_k_ret_po1
    s_sub_u32 s80, s80, 1
    s_cbranch_scc0 L_k_spin_po1
    s_endpgm
L_k_spin_pw1:
    ds_read_b32 v71, v0 offset:80
    s_waitcnt lgkmcnt(0)
    v_cmp_gt_u32 vcc, 2, v71
    s_cbranch_vccz L_k_ret_pw1
    s_sub_u32 s80, s80, 1
    s_cbranch_scc0 L_k_spin_pw1
    s_endpgm
L_k_spin_po2:
    ds_read_b32 v70, v0 offset:112
    s_waitcnt lgkmcnt(0)
    v_cmp_gt_u32 vcc, 4, v70
    s_cbranch_vccz L_k_ret_po2
    s_sub_u32 s80, s80, 1
    s_cbranch_scc0 L_k_spin_po2
    s_endpgm
L_k_spin_pw2:
    ds_read_b32 v71, v0 offset:84
    s_waitcnt lgkmcnt(0)
    v_cmp_gt_u32 vcc, 2, v71
    s_cbranch_vccz L_k_ret_pw2
    s_sub_u32 s80, s80, 1
    s_cbranch_scc0 L_k_spin_pw2
    s_endpgm
L_k_spin_po3:
    ds_read_b32 v70, v0 offset:112
    s_waitcnt lgkmcnt(0)
    v_cmp_gt_u32 vcc, 5, v70
    s_cbranch_vccz L_k_ret_po3
    s_sub_u32 s80, s80, 1
    s_cbranch_scc0 L_k_spin_po3
    s_endpgm
L_k_spin_pw3:
    ds_read_b32 v71, v0 offset:80
    s_waitcnt lgkmcnt(0)
    v_cmp_gt_u32 vcc, 3, v71
    s_cbranch_vccz L_k_ret_pw3
    s_sub_u32 s80, s80, 1
    s_cbranch_scc0 L_k_spin_pw3
    s_endpgm
L_k_spin_po4:
    ds_read_b32 v70, v0 offset:112
    s_waitcnt lgkmcnt(0)
    v_cmp_gt_u32 vcc, 6, v70
    s_cbranch_vccz L_k_ret_po4
    s_sub_u32 s80, s80, 1
    s_cbranch_scc0 L_k_spin_po4
    s_endpgm
L_k_spin_pw4:
    ds_read_b32 v71, v0 offset:84
    s_waitcnt lgkmcnt(0)
    v_cmp_gt_u32 vcc, 3, v71
    s_cbranch_vccz L_k_ret_pw4
    s_sub_u32 s80, s80, 1
    s_cbranch_scc0 L_k_spin_pw4
    s_endpgm
L_k_spin_po5:
    ds_read_b32 v70, v0 offset:112
    s_waitcnt lgkmcnt(0)
    v_cmp_gt_u32 vcc, 7, v70
    s_cbranch_vccz L_k_ret_po5
    s_sub_u32 s80, s80, 1
    s_cbranch_scc0 L_k_spin_po5
    s_endpgm
L_k_spin_pw5:
    ds_read_b32 v71, v0 offset:80
    s_waitcnt lgkmcnt(0)
    v_cmp_gt_u32 vcc, 4, v71
    s_cbranch_vccz L_k_ret_pw5
    s_sub_u32 s80, s80, 1
    s_cbranch_scc0 L_k_spin_pw5
    s_endpgm
L_k_spin_pw6:
    ds_read_b32 v71, v0 offset:84
    s_waitcnt lgkmcnt(0)
    v_cmp_gt_u32 vcc, 4, v71
    s_cbranch_vccz L_k_ret_pw6
    s_sub_u32 s80, s80, 1
    s_cbranch_scc0 L_k_spin_pw6
    s_endpgm
L_k_codeend:

.section .rodata,"a"
.p2align 6
.amdhsa_kernel standalone__mha_block_cached__near_ridge_kernel
  .amdhsa_next_free_vgpr 256
  .amdhsa_next_free_sgpr 102
  .amdhsa_accum_offset 216
  .amdhsa_group_segment_fixed_size 0
  .amdhsa_kernarg_size 64
  .amdhsa_user_sgpr_count 2
  .amdhsa_user_sgpr_kernarg_segment_ptr 1
  .amdhsa_system_sgpr_workgroup_id_x 1
.end_amdhsa_kernel
```
